```python
import torch

def _softmax(x, axis=-1):
    return torch.softmax(x, dim=axis)
def _gelu(x):
    return torch.nn.functional.gelu(x, approximate="tanh")
def _silu(x):
    return torch.nn.functional.silu(x)
def _sigmoid(x):
    return torch.sigmoid(x)
def _layernorm(x, axis=-1, eps=1e-5):
    m = x.mean(dim=axis, keepdim=True)
    v = x.var(dim=axis, keepdim=True, unbiased=False)
    return (x - m) / torch.sqrt(v + eps)
def _scatter_add(tgt, idx, src, axis=0):
    return tgt.clone().index_add_(axis, idx, src)
def _segment_sum(src, seg, n):
    out = torch.zeros((n,) + src.shape[1:], dtype=src.dtype)
    return out.index_add_(0, seg, src)
def _pad(x, pw):
    flat = tuple(v for pair in reversed(pw) for v in pair)
    return torch.nn.functional.pad(x, flat)

kernel_name = 'standalone__softmax_full_mha__prompt'

def setup_inputs():

    _w = (lambda a: (lambda t: t.to(torch.bfloat16) if t.is_floating_point() else t)(torch.as_tensor(a)))
    B, S, D = 1, 2048, 640
    return {
        "x": _w((lambda *s: torch.randn(*s, dtype=torch.bfloat16) * 0.2)(B, S, D)),
        "wqkv": _w((lambda *s: torch.randn(*s, dtype=torch.bfloat16) * 0.2)(D, 3 * D)),
        "wo": _w((lambda *s: torch.randn(*s, dtype=torch.bfloat16) * 0.05)(D, D)),
    }

def reference(x, wqkv, wo):
    B, S, D = x.shape
    H = 32; Dh = D // H
    qkv = (lambda x, *d: x.permute(*d))((x @ wqkv).reshape(B, S, 3, H, Dh), 2, 0, 3, 1, 4)
    q, k, v = qkv[0], qkv[1], qkv[2]
    scale = Dh ** -0.5
    scores = torch.einsum("bhqd,bhkd->bhqk", q, k) * scale
    p = _softmax(scores, axis=-1)
    o = torch.einsum("bhqk,bhkd->bhqd", p, v)
    return (lambda x, *d: x.permute(*d))(o, 0, 2, 1, 3).reshape(B, S, D) @ wo
```

```asm
; @launch grid=(256,1,1) block=(576,1,1) lds=163840
.amdgcn_target "amdgcn-amd-amdhsa--gfx950"
.text
.p2align 12
.globl standalone__softmax_full_mha__prompt_kernel
.p2align 8
.type standalone__softmax_full_mha__prompt_kernel,@function
standalone__softmax_full_mha__prompt_kernel:
    s_load_dwordx2 s[16:17], s[0:1], 0
    s_load_dwordx2 s[20:21], s[0:1], 8
    s_load_dwordx2 s[24:25], s[0:1], 40
    v_lshrrev_b32 v1, 6, v0
    s_cmpk_ge_u32 s2, 256
    s_cbranch_scc1 L_end
    v_readfirstlane_b32 s40, v1
    v_and_b32 v0, 63, v0
    s_lshr_b32 s47, s2, 3
    s_bfe_u32 s48, s2, 0x10002
    s_mul_i32 s48, s48, 30
    s_add_u32 s47, s47, s48
    s_lshr_b32 s42, s47, 2
    s_and_b32 s47, s47, 3
    s_and_b32 s41, s2, 3
    s_lshl2_add_u32 s41, s41, s47
    s_mov_b32 s26, 14450688
    s_mov_b32 s27, 0x00020000
    s_cmp_ge_u32 s40, 4
    s_cbranch_scc1 L_notloader
    s_cmpk_ge_u32 s2, 240
    s_cbranch_scc1 L_woimg
    v_lshrrev_b32 v1, 3, v0
    v_lshrrev_b32 v2, 4, v0
    v_and_b32 v3, 7, v0
    v_xor_b32 v3, v3, v2
    s_lshl2_add_u32 s48, s41, s40
    s_lshl_b32 s48, s48, 5
    v_add_u32 v1, s48, v1
    v_mul_u32_u24 v1, 1280, v1
    v_lshl_add_u32 v4, v3, 4, v1
    v_xor_b32 v5, 64, v4
    s_movk_i32 s48, 9216
    v_add_u32 v5, s48, v5
    v_lshl_add_u32 v6, s48, 1, v4
    v_lshl_add_u32 v7, s48, 1, v5
    s_mov_b32 s18, 2621440
    s_mov_b32 s19, s27
    s_mov_b32 s22, 2457600
    s_mov_b32 s23, s27
    s_lshl_b32 s49, s40, 12
    s_add_u32 s47, s47, s42
    s_mul_i32 s47, s47, 3
    s_mov_b32 s50, 0xc6633198
    s_mov_b32 s51, 0x33198c
    s_lshr_b64 s[50:51], s[50:51], s47
    s_and_b32 s47, s50, 7
    s_lshl_b32 s50, s47, 7
    s_mov_b32 m0, s49
    s_waitcnt lgkmcnt(0)
    s_mul_i32 s51, s50, 1920
    buffer_load_dwordx4 v4, s[16:19], s50 offen offset:0 lds
    buffer_load_dwordx4 v5, s[16:19], s50 offen offset:1024 lds
    buffer_load_dwordx4 v6, s[16:19], s50 offen offset:2048 lds
    buffer_load_dwordx4 v7, s[16:19], s50 offen offset:3072 lds
    v_lshlrev_b32 v1, 1, v2
    v_and_b32 v3, 15, v0
    v_xor_b32 v3, v3, v1
    s_lshl_b32 s47, s40, 4
    v_add_u32 v2, s47, v2
    v_mul_u32_u24 v2, 3840, v2
    s_lshl_b32 s47, s42, 8
    v_lshl_add_u32 v2, v3, 4, v2
    v_add_u32 v8, s47, v2
    s_movk_i32 s48, 14336
    v_add_u32 v9, s48, v8
    v_add_u32 v10, s48, v9
    v_xor_b32 v10, 0x80, v10
    v_add_u32 v11, s48, v10
    s_add_u32 m0, s49, 16384
    s_addk_i32 s50, 128
    buffer_load_dwordx4 v8, s[20:23], s51 offen offset:0 lds
    buffer_load_dwordx4 v9, s[20:23], s51 offen offset:1024 lds
    buffer_load_dwordx4 v10, s[20:23], s51 offen offset:2048 lds
    buffer_load_dwordx4 v11, s[20:23], s51 offen offset:3072 lds
    s_cmpk_eq_u32 s50, 1280
    s_cselect_b32 s50, 0, s50
    s_add_u32 m0, s49, 32768
    s_mul_i32 s51, s50, 1920
    buffer_load_dwordx4 v4, s[16:19], s50 offen offset:0 lds
    buffer_load_dwordx4 v5, s[16:19], s50 offen offset:1024 lds
    buffer_load_dwordx4 v6, s[16:19], s50 offen offset:2048 lds
    buffer_load_dwordx4 v7, s[16:19], s50 offen offset:3072 lds
    s_add_u32 m0, s49, 49152
    s_addk_i32 s50, 128
    buffer_load_dwordx4 v8, s[20:23], s51 offen offset:0 lds
    buffer_load_dwordx4 v9, s[20:23], s51 offen offset:1024 lds
    buffer_load_dwordx4 v10, s[20:23], s51 offen offset:2048 lds
    buffer_load_dwordx4 v11, s[20:23], s51 offen offset:3072 lds
    s_cmpk_eq_u32 s50, 1280
    s_cselect_b32 s50, 0, s50
    s_waitcnt vmcnt(8)
    s_barrier
    s_add_u32 m0, s49, 65536
    s_mul_i32 s51, s50, 1920
    buffer_load_dwordx4 v4, s[16:19], s50 offen offset:0 lds
    buffer_load_dwordx4 v5, s[16:19], s50 offen offset:1024 lds
    buffer_load_dwordx4 v6, s[16:19], s50 offen offset:2048 lds
    buffer_load_dwordx4 v7, s[16:19], s50 offen offset:3072 lds
    s_add_u32 m0, s49, 81920
    s_addk_i32 s50, 128
    buffer_load_dwordx4 v8, s[20:23], s51 offen offset:0 lds
    buffer_load_dwordx4 v9, s[20:23], s51 offen offset:1024 lds
    buffer_load_dwordx4 v10, s[20:23], s51 offen offset:2048 lds
    buffer_load_dwordx4 v11, s[20:23], s51 offen offset:3072 lds
    s_cmpk_eq_u32 s50, 1280
    s_cselect_b32 s50, 0, s50
    s_waitcnt vmcnt(8)
    s_barrier
    s_add_u32 m0, s49, 0
    s_mul_i32 s51, s50, 1920
    buffer_load_dwordx4 v4, s[16:19], s50 offen offset:0 lds
    buffer_load_dwordx4 v5, s[16:19], s50 offen offset:1024 lds
    buffer_load_dwordx4 v6, s[16:19], s50 offen offset:2048 lds
    buffer_load_dwordx4 v7, s[16:19], s50 offen offset:3072 lds
    s_add_u32 m0, s49, 16384
    s_addk_i32 s50, 128
    buffer_load_dwordx4 v8, s[20:23], s51 offen offset:0 lds
    buffer_load_dwordx4 v9, s[20:23], s51 offen offset:1024 lds
    buffer_load_dwordx4 v10, s[20:23], s51 offen offset:2048 lds
    buffer_load_dwordx4 v11, s[20:23], s51 offen offset:3072 lds
    s_cmpk_eq_u32 s50, 1280
    s_cselect_b32 s50, 0, s50
    s_waitcnt vmcnt(8)
    s_barrier
    s_add_u32 m0, s49, 32768
    s_mul_i32 s51, s50, 1920
    buffer_load_dwordx4 v4, s[16:19], s50 offen offset:0 lds
    buffer_load_dwordx4 v5, s[16:19], s50 offen offset:1024 lds
    buffer_load_dwordx4 v6, s[16:19], s50 offen offset:2048 lds
    buffer_load_dwordx4 v7, s[16:19], s50 offen offset:3072 lds
    s_add_u32 m0, s49, 49152
    s_addk_i32 s50, 128
    buffer_load_dwordx4 v8, s[20:23], s51 offen offset:0 lds
    buffer_load_dwordx4 v9, s[20:23], s51 offen offset:1024 lds
    buffer_load_dwordx4 v10, s[20:23], s51 offen offset:2048 lds
    buffer_load_dwordx4 v11, s[20:23], s51 offen offset:3072 lds
    s_cmpk_eq_u32 s50, 1280
    s_cselect_b32 s50, 0, s50
    s_waitcnt vmcnt(8)
    s_barrier
    s_add_u32 m0, s49, 65536
    s_mul_i32 s51, s50, 1920
    buffer_load_dwordx4 v4, s[16:19], s50 offen offset:0 lds
    buffer_load_dwordx4 v5, s[16:19], s50 offen offset:1024 lds
    buffer_load_dwordx4 v6, s[16:19], s50 offen offset:2048 lds
    buffer_load_dwordx4 v7, s[16:19], s50 offen offset:3072 lds
    s_add_u32 m0, s49, 81920
    s_addk_i32 s50, 128
    buffer_load_dwordx4 v8, s[20:23], s51 offen offset:0 lds
    buffer_load_dwordx4 v9, s[20:23], s51 offen offset:1024 lds
    buffer_load_dwordx4 v10, s[20:23], s51 offen offset:2048 lds
    buffer_load_dwordx4 v11, s[20:23], s51 offen offset:3072 lds
    s_cmpk_eq_u32 s50, 1280
    s_cselect_b32 s50, 0, s50
    s_waitcnt vmcnt(8)
    s_barrier
    s_add_u32 m0, s49, 0
    s_mul_i32 s51, s50, 1920
    buffer_load_dwordx4 v4, s[16:19], s50 offen offset:0 lds
    buffer_load_dwordx4 v5, s[16:19], s50 offen offset:1024 lds
    buffer_load_dwordx4 v6, s[16:19], s50 offen offset:2048 lds
    buffer_load_dwordx4 v7, s[16:19], s50 offen offset:3072 lds
    s_add_u32 m0, s49, 16384
    s_addk_i32 s50, 128
    buffer_load_dwordx4 v8, s[20:23], s51 offen offset:0 lds
    buffer_load_dwordx4 v9, s[20:23], s51 offen offset:1024 lds
    buffer_load_dwordx4 v10, s[20:23], s51 offen offset:2048 lds
    buffer_load_dwordx4 v11, s[20:23], s51 offen offset:3072 lds
    s_cmpk_eq_u32 s50, 1280
    s_cselect_b32 s50, 0, s50
    s_waitcnt vmcnt(8)
    s_barrier
    s_add_u32 m0, s49, 32768
    s_mul_i32 s51, s50, 1920
    buffer_load_dwordx4 v4, s[16:19], s50 offen offset:0 lds
    buffer_load_dwordx4 v5, s[16:19], s50 offen offset:1024 lds
    buffer_load_dwordx4 v6, s[16:19], s50 offen offset:2048 lds
    buffer_load_dwordx4 v7, s[16:19], s50 offen offset:3072 lds
    s_add_u32 m0, s49, 49152
    s_addk_i32 s50, 128
    buffer_load_dwordx4 v8, s[20:23], s51 offen offset:0 lds
    buffer_load_dwordx4 v9, s[20:23], s51 offen offset:1024 lds
    buffer_load_dwordx4 v10, s[20:23], s51 offen offset:2048 lds
    buffer_load_dwordx4 v11, s[20:23], s51 offen offset:3072 lds
    s_cmpk_eq_u32 s50, 1280
    s_cselect_b32 s50, 0, s50
    s_waitcnt vmcnt(8)
    s_barrier
    s_add_u32 m0, s49, 65536
    s_mul_i32 s51, s50, 1920
    buffer_load_dwordx4 v4, s[16:19], s50 offen offset:0 lds
    buffer_load_dwordx4 v5, s[16:19], s50 offen offset:1024 lds
    buffer_load_dwordx4 v6, s[16:19], s50 offen offset:2048 lds
    buffer_load_dwordx4 v7, s[16:19], s50 offen offset:3072 lds
    s_add_u32 m0, s49, 81920
    s_addk_i32 s50, 128
    buffer_load_dwordx4 v8, s[20:23], s51 offen offset:0 lds
    buffer_load_dwordx4 v9, s[20:23], s51 offen offset:1024 lds
    buffer_load_dwordx4 v10, s[20:23], s51 offen offset:2048 lds
    buffer_load_dwordx4 v11, s[20:23], s51 offen offset:3072 lds
    s_cmpk_eq_u32 s50, 1280
    s_cselect_b32 s50, 0, s50
    s_waitcnt vmcnt(8)
    s_barrier
    s_add_u32 m0, s49, 0
    s_mul_i32 s51, s50, 1920
    buffer_load_dwordx4 v4, s[16:19], s50 offen offset:0 lds
    buffer_load_dwordx4 v5, s[16:19], s50 offen offset:1024 lds
    buffer_load_dwordx4 v6, s[16:19], s50 offen offset:2048 lds
    buffer_load_dwordx4 v7, s[16:19], s50 offen offset:3072 lds
    s_add_u32 m0, s49, 16384
    s_addk_i32 s50, 128
    buffer_load_dwordx4 v8, s[20:23], s51 offen offset:0 lds
    buffer_load_dwordx4 v9, s[20:23], s51 offen offset:1024 lds
    buffer_load_dwordx4 v10, s[20:23], s51 offen offset:2048 lds
    buffer_load_dwordx4 v11, s[20:23], s51 offen offset:3072 lds
    s_waitcnt vmcnt(8)
    s_barrier
    s_waitcnt vmcnt(0)
    s_barrier
    s_branch L_b1
L_notloader:
    s_cmp_eq_u32 s40, 8
    s_cbranch_scc1 L_service
    s_cmpk_ge_u32 s2, 240
    s_cbranch_scc1 L_woimg
    s_and_b32 s47, s40, 1
    s_bfe_u32 s48, s40, 0x10001
    s_mul_i32 s49, s42, 13
    s_lshr_b32 s49, s49, 6
    s_mul_i32 s50, s49, 5
    s_sub_u32 s50, s42, s50
    s_cmp_eq_u32 s49, 2
    s_cselect_b32 s51, 5, s50
    s_lshl1_add_u32 s51, s51, s48
    s_mov_b32 s56, 0x45074402
    s_mov_b32 s57, 0x66286123
    s_mov_b32 s58, 0x1f114c0a
    s_mov_b32 s59, 0x3e306d2b
    s_cmp_eq_u32 s51, 1
    s_cmov_b32 s56, 0x591c164f
    s_cmov_b32 s57, 0x7a3d3873
    s_cmov_b32 s58, 0x559b8e80
    s_cmov_b32 s59, 0x77949289
    s_cmp_eq_u32 s51, 2
    s_cmov_b32 s56, 0x8470641
    s_cmov_b32 s57, 0x2b652462
    s_cmov_b32 s58, 0x144e0f49
    s_cmov_b32 s59, 0x33702d6a
    s_cmp_eq_u32 s51, 3
    s_cmov_b32 s56, 0x5e1f5819
    s_cmov_b32 s57, 0x7c3d7a3b
    s_cmov_b32 s58, 0x55928380
    s_cmov_b32 s59, 0x7697918c
    s_cmp_eq_u32 s51, 4
    s_cmov_b32 s56, 0x48074502
    s_cmov_b32 s57, 0x69266324
    s_cmov_b32 s58, 0x53124c0d
    s_cmov_b32 s59, 0x70316e2f
    s_cmp_eq_u32 s51, 5
    s_cmov_b32 s56, 0x5a1c5715
    s_cmov_b32 s57, 0x7b3e7839
    s_cmov_b32 s58, 0x9d8b8a80
    s_cmov_b32 s59, 0x9f969481
    s_cmp_eq_u32 s51, 6
    s_cmov_b32 s56, 0x47044201
    s_cmov_b32 s57, 0x66256023
    s_cmov_b32 s58, 0x51104a0b
    s_cmov_b32 s59, 0x6e2f6c2d
    s_cmp_eq_u32 s51, 7
    s_cmov_b32 s56, 0x581a5513
    s_cmov_b32 s57, 0x793c7637
    s_cmov_b32 s58, 0x1d9b9288
    s_cmov_b32 s59, 0x3e9f9489
    s_cmp_eq_u32 s51, 8
    s_cmov_b32 s56, 0xd430240
    s_cmov_b32 s57, 0x2f642661
    s_cmov_b32 s58, 0x5c1e1107
    s_cmov_b32 s59, 0x7b3d3228
    s_cmp_eq_u32 s51, 9
    s_cmov_b32 s56, 0x5718554a
    s_cmov_b32 s57, 0x7936746b
    s_cmov_b32 s58, 0x4c9a9385
    s_cmov_b32 s59, 0x6e9f9089
    s_cmp_eq_u32 s51, 10
    s_cmov_b32 s56, 0x3020100
    s_cmov_b32 s57, 0x7060504
    s_cmov_b32 s58, 0xb0a0908
    s_cmov_b32 s59, 0xf0e0d0c
    s_cmp_eq_u32 s51, 11
    s_cmov_b32 s56, 0x13121110
    s_cmov_b32 s57, 0x17161514
    s_cmov_b32 s58, 0x1b1a1918
    s_cmov_b32 s59, 0x1f1e1d1c
    v_and_b32 v2, 15, v0
    v_lshrrev_b32 v3, 4, v0
    v_lshrrev_b32 v152, 1, v2
    v_xor_b32 v152, v152, v3
    s_lshl_b32 s52, s47, 13
    v_lshl_add_u32 v153, v2, 7, s52
    v_lshl_add_u32 v132, v152, 4, v153
    v_xor_b32 v133, 64, v132
    v_bfe_u32 v152, v0, 2, 2
    v_lshl_add_u32 v153, v3, 3, v152
    v_add_lshl_u32 v153, v153, 64, 8
    v_bfe_u32 v152, v0, 2, 3
    v_lshlrev_b32 v152, 5, v152
    v_and_b32 v154, 3, v0
    v_lshlrev_b32 v154, 3, v154
    s_mov_b32 s52, 0x10000
    v_bfe_u32 v156, s56, v154, 5
    v_lshlrev_b32 v156, 3, v156
    v_xor_b32 v156, v156, v152
    v_add_u32 v136, v156, v153
    v_add_u32 v140, s52, v136
    v_bfe_u32 v156, s57, v154, 5
    v_lshlrev_b32 v156, 3, v156
    v_xor_b32 v156, v156, v152
    v_add_u32 v137, v156, v153
    v_add_u32 v141, s52, v137
    v_bfe_u32 v156, s58, v154, 5
    v_lshlrev_b32 v156, 3, v156
    v_xor_b32 v156, v156, v152
    v_add_u32 v138, v156, v153
    v_add_u32 v142, s52, v138
    v_bfe_u32 v156, s59, v154, 5
    v_lshlrev_b32 v156, 3, v156
    v_xor_b32 v156, v156, v152
    v_add_u32 v139, v156, v153
    v_add_u32 v143, s52, v139
    v_add_u32 v134, s52, v132
    v_add_u32 v135, s52, v133
    s_mul_i32 s60, s41, 10240
    s_mov_b32 s61, 163840
    v_mov_b64 v[68:69], 0
    v_mov_b64 v[70:71], 0
    v_mov_b64 v[72:73], 0
    v_mov_b64 v[74:75], 0
    v_mov_b64 v[76:77], 0
    v_mov_b64 v[78:79], 0
    v_mov_b64 v[80:81], 0
    v_mov_b64 v[82:83], 0
    v_mov_b64 v[84:85], 0
    v_mov_b64 v[86:87], 0
    v_mov_b64 v[88:89], 0
    v_mov_b64 v[90:91], 0
    v_mov_b64 v[92:93], 0
    v_mov_b64 v[94:95], 0
    v_mov_b64 v[96:97], 0
    v_mov_b64 v[98:99], 0
    v_mov_b64 v[100:101], 0
    v_mov_b64 v[102:103], 0
    v_mov_b64 v[104:105], 0
    v_mov_b64 v[106:107], 0
    v_mov_b64 v[108:109], 0
    v_mov_b64 v[110:111], 0
    v_mov_b64 v[112:113], 0
    v_mov_b64 v[114:115], 0
    v_mov_b64 v[116:117], 0
    v_mov_b64 v[118:119], 0
    v_mov_b64 v[120:121], 0
    v_mov_b64 v[122:123], 0
    v_mov_b64 v[124:125], 0
    v_mov_b64 v[126:127], 0
    v_mov_b64 v[128:129], 0
    v_mov_b64 v[130:131], 0
    s_cmp_eq_u32 s49, 2
    s_cbranch_scc1 L_vpath
    s_cmp_eq_u32 s49, 0
    s_cselect_b32 s52, 5242880, 0
    s_cselect_b32 s54, 0x3ea52b5c, 1.0
    s_mov_b32 s55, s54
    s_add_u32 s60, s60, s52
    s_lshl_b32 s52, s50, 5
    v_lshlrev_b32 v154, 3, v3
    s_lshl_b32 s53, s47, 11
    v_lshl_add_u32 v158, v2, 4, s53
    s_lshl_b32 s53, s47, 9
    s_add_u32 s53, s53, 4096
    v_lshl_add_u32 v159, v2, 3, s53
    v_bfe_u32 v156, s56, v154, 8
    v_and_b32 v157, 31, v156
    v_cmp_gt_u32 vcc, 128, v156
    v_add_u32 v157, s52, v157
    v_mul_u32_u24 v157, 205, v157
    v_lshrrev_b32 v157, 10, v157
    v_mul_lo_u32 v157, v157, s61
    v_lshrrev_b32 v156, 6, v156
    v_lshl_add_u32 v157, v156, 9, v157
    v_add_u32 v157, v157, v158
    v_cndmask_b32 v144, 2.0, v157, vcc
    v_bfe_u32 v156, s58, v154, 8
    v_and_b32 v157, 31, v156
    v_cmp_gt_u32 vcc, 128, v156
    v_add_u32 v157, s52, v157
    v_mul_u32_u24 v157, 205, v157
    v_lshrrev_b32 v157, 10, v157
    v_mul_lo_u32 v157, v157, s61
    v_add_u32 v146, v157, v159
    v_cndmask_b32 v146, v146, 2.0, vcc
    v_lshrrev_b32 v156, 6, v156
    v_lshl_add_u32 v157, v156, 9, v157
    v_add_u32 v157, v157, v158
    v_cndmask_b32 v145, 2.0, v157, vcc
    v_bfe_u32 v156, s59, v154, 8
    v_and_b32 v157, 31, v156
    v_cmp_gt_u32 vcc, 128, v156
    v_add_u32 v157, s52, v157
    v_mul_u32_u24 v157, 205, v157
    v_lshrrev_b32 v157, 10, v157
    v_mul_lo_u32 v157, v157, s61
    v_add_u32 v147, v157, v159
    v_cndmask_b32 v147, v147, 2.0, vcc
    s_mov_b32 s62, 2
    s_branch L_qk2
.p2align 12
L_qk2:
L_pad0:
    s_cbranch_execz L_padret
    s_waitcnt lgkmcnt(0)
    s_barrier
    ds_read_b128 v[4:7], v132 offset:0
    ds_read_b64_tr_b16 v[20:21], v136 offset:0
    ds_read_b64_tr_b16 v[22:23], v136 offset:1024
    ds_read_b64_tr_b16 v[24:25], v137 offset:0
    ds_read_b64_tr_b16 v[26:27], v137 offset:1024
    ds_read_b64_tr_b16 v[28:29], v138 offset:0
    ds_read_b64_tr_b16 v[30:31], v138 offset:1024
    ds_read_b64_tr_b16 v[32:33], v139 offset:0
    ds_read_b64_tr_b16 v[34:35], v139 offset:1024
    ds_read_b128 v[8:11], v132 offset:2048
    ds_read_b128 v[12:15], v132 offset:4096
    ds_read_b128 v[16:19], v132 offset:6144
L_glq:
    s_waitcnt lgkmcnt(9)
    v_mfma_f32_16x16x32_bf16 v[68:71], v[20:23], v[4:7], v[68:71]
    ds_read_b128 v[36:39], v133 offset:0
    s_waitcnt lgkmcnt(8)
    v_mfma_f32_16x16x32_bf16 v[72:75], v[24:27], v[4:7], v[72:75]
    ds_read_b64_tr_b16 v[52:53], v136 offset:8192
    s_waitcnt lgkmcnt(7)
    v_mfma_f32_16x16x32_bf16 v[76:79], v[28:31], v[4:7], v[76:79]
    ds_read_b64_tr_b16 v[54:55], v136 offset:9216
    s_waitcnt lgkmcnt(6)
    v_mfma_f32_16x16x32_bf16 v[80:83], v[32:35], v[4:7], v[80:83]
    ds_read_b64_tr_b16 v[56:57], v137 offset:8192
    s_waitcnt lgkmcnt(6)
    v_mfma_f32_16x16x32_bf16 v[84:87], v[20:23], v[8:11], v[84:87]
    ds_read_b64_tr_b16 v[58:59], v137 offset:9216
    v_mfma_f32_16x16x32_bf16 v[88:91], v[24:27], v[8:11], v[88:91]
    ds_read_b64_tr_b16 v[60:61], v138 offset:8192
    v_mfma_f32_16x16x32_bf16 v[92:95], v[28:31], v[8:11], v[92:95]
    ds_read_b64_tr_b16 v[62:63], v138 offset:9216
    v_mfma_f32_16x16x32_bf16 v[96:99], v[32:35], v[8:11], v[96:99]
    ds_read_b64_tr_b16 v[64:65], v139 offset:8192
    s_waitcnt lgkmcnt(9)
    v_mfma_f32_16x16x32_bf16 v[100:103], v[20:23], v[12:15], v[100:103]
    ds_read_b64_tr_b16 v[66:67], v139 offset:9216
    v_mfma_f32_16x16x32_bf16 v[104:107], v[24:27], v[12:15], v[104:107]
    ds_read_b128 v[40:43], v133 offset:2048
    v_mfma_f32_16x16x32_bf16 v[108:111], v[28:31], v[12:15], v[108:111]
    ds_read_b128 v[44:47], v133 offset:4096
    v_mfma_f32_16x16x32_bf16 v[112:115], v[32:35], v[12:15], v[112:115]
    ds_read_b128 v[48:51], v133 offset:6144
    s_waitcnt lgkmcnt(12)
    v_mfma_f32_16x16x32_bf16 v[116:119], v[20:23], v[16:19], v[116:119]
    v_mfma_f32_16x16x32_bf16 v[120:123], v[24:27], v[16:19], v[120:123]
    v_mfma_f32_16x16x32_bf16 v[124:127], v[28:31], v[16:19], v[124:127]
    v_mfma_f32_16x16x32_bf16 v[128:131], v[32:35], v[16:19], v[128:131]
    s_waitcnt lgkmcnt(9)
    v_mfma_f32_16x16x32_bf16 v[68:71], v[52:55], v[36:39], v[68:71]
    s_waitcnt lgkmcnt(7)
    v_mfma_f32_16x16x32_bf16 v[72:75], v[56:59], v[36:39], v[72:75]
    s_waitcnt lgkmcnt(5)
    v_mfma_f32_16x16x32_bf16 v[76:79], v[60:63], v[36:39], v[76:79]
    s_waitcnt lgkmcnt(3)
    v_mfma_f32_16x16x32_bf16 v[80:83], v[64:67], v[36:39], v[80:83]
    s_waitcnt lgkmcnt(2)
    v_mfma_f32_16x16x32_bf16 v[84:87], v[52:55], v[40:43], v[84:87]
    v_mfma_f32_16x16x32_bf16 v[88:91], v[56:59], v[40:43], v[88:91]
    v_mfma_f32_16x16x32_bf16 v[92:95], v[60:63], v[40:43], v[92:95]
    v_mfma_f32_16x16x32_bf16 v[96:99], v[64:67], v[40:43], v[96:99]
    s_waitcnt lgkmcnt(0)
    s_barrier
    v_mfma_f32_16x16x32_bf16 v[100:103], v[52:55], v[44:47], v[100:103]
    ds_read_b128 v[4:7], v132 offset:32768
    ds_read_b64_tr_b16 v[20:21], v136 offset:32768
    v_mfma_f32_16x16x32_bf16 v[104:107], v[56:59], v[44:47], v[104:107]
    ds_read_b64_tr_b16 v[22:23], v136 offset:33792
    ds_read_b64_tr_b16 v[24:25], v137 offset:32768
    v_mfma_f32_16x16x32_bf16 v[108:111], v[60:63], v[44:47], v[108:111]
    ds_read_b64_tr_b16 v[26:27], v137 offset:33792
    ds_read_b64_tr_b16 v[28:29], v138 offset:32768
    v_mfma_f32_16x16x32_bf16 v[112:115], v[64:67], v[44:47], v[112:115]
    ds_read_b64_tr_b16 v[30:31], v138 offset:33792
    ds_read_b64_tr_b16 v[32:33], v139 offset:32768
    v_mfma_f32_16x16x32_bf16 v[116:119], v[52:55], v[48:51], v[116:119]
    ds_read_b64_tr_b16 v[34:35], v139 offset:33792
    v_mfma_f32_16x16x32_bf16 v[120:123], v[56:59], v[48:51], v[120:123]
    ds_read_b128 v[8:11], v132 offset:34816
    v_mfma_f32_16x16x32_bf16 v[124:127], v[60:63], v[48:51], v[124:127]
    ds_read_b128 v[12:15], v132 offset:36864
    v_mfma_f32_16x16x32_bf16 v[128:131], v[64:67], v[48:51], v[128:131]
    ds_read_b128 v[16:19], v132 offset:38912
    s_waitcnt lgkmcnt(9)
    v_mfma_f32_16x16x32_bf16 v[68:71], v[20:23], v[4:7], v[68:71]
    ds_read_b128 v[36:39], v133 offset:32768
    s_waitcnt lgkmcnt(8)
    v_mfma_f32_16x16x32_bf16 v[72:75], v[24:27], v[4:7], v[72:75]
    ds_read_b64_tr_b16 v[52:53], v136 offset:40960
    s_waitcnt lgkmcnt(7)
    v_mfma_f32_16x16x32_bf16 v[76:79], v[28:31], v[4:7], v[76:79]
    ds_read_b64_tr_b16 v[54:55], v136 offset:41984
    s_waitcnt lgkmcnt(6)
    v_mfma_f32_16x16x32_bf16 v[80:83], v[32:35], v[4:7], v[80:83]
    ds_read_b64_tr_b16 v[56:57], v137 offset:40960
    s_waitcnt lgkmcnt(6)
    v_mfma_f32_16x16x32_bf16 v[84:87], v[20:23], v[8:11], v[84:87]
    ds_read_b64_tr_b16 v[58:59], v137 offset:41984
    v_mfma_f32_16x16x32_bf16 v[88:91], v[24:27], v[8:11], v[88:91]
    ds_read_b64_tr_b16 v[60:61], v138 offset:40960
    v_mfma_f32_16x16x32_bf16 v[92:95], v[28:31], v[8:11], v[92:95]
    ds_read_b64_tr_b16 v[62:63], v138 offset:41984
    v_mfma_f32_16x16x32_bf16 v[96:99], v[32:35], v[8:11], v[96:99]
    ds_read_b64_tr_b16 v[64:65], v139 offset:40960
    s_waitcnt lgkmcnt(9)
    v_mfma_f32_16x16x32_bf16 v[100:103], v[20:23], v[12:15], v[100:103]
    ds_read_b64_tr_b16 v[66:67], v139 offset:41984
    v_mfma_f32_16x16x32_bf16 v[104:107], v[24:27], v[12:15], v[104:107]
    ds_read_b128 v[40:43], v133 offset:34816
    v_mfma_f32_16x16x32_bf16 v[108:111], v[28:31], v[12:15], v[108:111]
    ds_read_b128 v[44:47], v133 offset:36864
    v_mfma_f32_16x16x32_bf16 v[112:115], v[32:35], v[12:15], v[112:115]
    ds_read_b128 v[48:51], v133 offset:38912
    s_waitcnt lgkmcnt(12)
    v_mfma_f32_16x16x32_bf16 v[116:119], v[20:23], v[16:19], v[116:119]
    v_mfma_f32_16x16x32_bf16 v[120:123], v[24:27], v[16:19], v[120:123]
    v_mfma_f32_16x16x32_bf16 v[124:127], v[28:31], v[16:19], v[124:127]
    v_mfma_f32_16x16x32_bf16 v[128:131], v[32:35], v[16:19], v[128:131]
    s_waitcnt lgkmcnt(9)
    v_mfma_f32_16x16x32_bf16 v[68:71], v[52:55], v[36:39], v[68:71]
    s_waitcnt lgkmcnt(7)
    v_mfma_f32_16x16x32_bf16 v[72:75], v[56:59], v[36:39], v[72:75]
    s_waitcnt lgkmcnt(5)
    v_mfma_f32_16x16x32_bf16 v[76:79], v[60:63], v[36:39], v[76:79]
    s_waitcnt lgkmcnt(3)
    v_mfma_f32_16x16x32_bf16 v[80:83], v[64:67], v[36:39], v[80:83]
    s_waitcnt lgkmcnt(2)
    v_mfma_f32_16x16x32_bf16 v[84:87], v[52:55], v[40:43], v[84:87]
    v_mfma_f32_16x16x32_bf16 v[88:91], v[56:59], v[40:43], v[88:91]
    v_mfma_f32_16x16x32_bf16 v[92:95], v[60:63], v[40:43], v[92:95]
    v_mfma_f32_16x16x32_bf16 v[96:99], v[64:67], v[40:43], v[96:99]
    s_waitcnt lgkmcnt(0)
    s_barrier
    v_mfma_f32_16x16x32_bf16 v[100:103], v[52:55], v[44:47], v[100:103]
    ds_read_b128 v[4:7], v134 offset:0
    ds_read_b64_tr_b16 v[20:21], v140 offset:0
    v_mfma_f32_16x16x32_bf16 v[104:107], v[56:59], v[44:47], v[104:107]
    ds_read_b64_tr_b16 v[22:23], v140 offset:1024
    ds_read_b64_tr_b16 v[24:25], v141 offset:0
    v_mfma_f32_16x16x32_bf16 v[108:111], v[60:63], v[44:47], v[108:111]
    ds_read_b64_tr_b16 v[26:27], v141 offset:1024
    ds_read_b64_tr_b16 v[28:29], v142 offset:0
    v_mfma_f32_16x16x32_bf16 v[112:115], v[64:67], v[44:47], v[112:115]
    ds_read_b64_tr_b16 v[30:31], v142 offset:1024
    ds_read_b64_tr_b16 v[32:33], v143 offset:0
    v_mfma_f32_16x16x32_bf16 v[116:119], v[52:55], v[48:51], v[116:119]
    ds_read_b64_tr_b16 v[34:35], v143 offset:1024
    v_mfma_f32_16x16x32_bf16 v[120:123], v[56:59], v[48:51], v[120:123]
    ds_read_b128 v[8:11], v134 offset:2048
    v_mfma_f32_16x16x32_bf16 v[124:127], v[60:63], v[48:51], v[124:127]
    ds_read_b128 v[12:15], v134 offset:4096
    v_mfma_f32_16x16x32_bf16 v[128:131], v[64:67], v[48:51], v[128:131]
    ds_read_b128 v[16:19], v134 offset:6144
    s_waitcnt lgkmcnt(9)
    v_mfma_f32_16x16x32_bf16 v[68:71], v[20:23], v[4:7], v[68:71]
    ds_read_b128 v[36:39], v135 offset:0
    s_waitcnt lgkmcnt(8)
    v_mfma_f32_16x16x32_bf16 v[72:75], v[24:27], v[4:7], v[72:75]
    ds_read_b64_tr_b16 v[52:53], v140 offset:8192
    s_waitcnt lgkmcnt(7)
    v_mfma_f32_16x16x32_bf16 v[76:79], v[28:31], v[4:7], v[76:79]
    ds_read_b64_tr_b16 v[54:55], v140 offset:9216
    s_waitcnt lgkmcnt(6)
    v_mfma_f32_16x16x32_bf16 v[80:83], v[32:35], v[4:7], v[80:83]
    ds_read_b64_tr_b16 v[56:57], v141 offset:8192
    s_waitcnt lgkmcnt(6)
    v_mfma_f32_16x16x32_bf16 v[84:87], v[20:23], v[8:11], v[84:87]
    ds_read_b64_tr_b16 v[58:59], v141 offset:9216
    v_mfma_f32_16x16x32_bf16 v[88:91], v[24:27], v[8:11], v[88:91]
    ds_read_b64_tr_b16 v[60:61], v142 offset:8192
    v_mfma_f32_16x16x32_bf16 v[92:95], v[28:31], v[8:11], v[92:95]
    ds_read_b64_tr_b16 v[62:63], v142 offset:9216
    v_mfma_f32_16x16x32_bf16 v[96:99], v[32:35], v[8:11], v[96:99]
    ds_read_b64_tr_b16 v[64:65], v143 offset:8192
    s_waitcnt lgkmcnt(9)
    v_mfma_f32_16x16x32_bf16 v[100:103], v[20:23], v[12:15], v[100:103]
    ds_read_b64_tr_b16 v[66:67], v143 offset:9216
    v_mfma_f32_16x16x32_bf16 v[104:107], v[24:27], v[12:15], v[104:107]
    ds_read_b128 v[40:43], v135 offset:2048
    v_mfma_f32_16x16x32_bf16 v[108:111], v[28:31], v[12:15], v[108:111]
    ds_read_b128 v[44:47], v135 offset:4096
    v_mfma_f32_16x16x32_bf16 v[112:115], v[32:35], v[12:15], v[112:115]
    ds_read_b128 v[48:51], v135 offset:6144
    s_waitcnt lgkmcnt(12)
    v_mfma_f32_16x16x32_bf16 v[116:119], v[20:23], v[16:19], v[116:119]
    v_mfma_f32_16x16x32_bf16 v[120:123], v[24:27], v[16:19], v[120:123]
    v_mfma_f32_16x16x32_bf16 v[124:127], v[28:31], v[16:19], v[124:127]
    v_mfma_f32_16x16x32_bf16 v[128:131], v[32:35], v[16:19], v[128:131]
    s_waitcnt lgkmcnt(9)
    v_mfma_f32_16x16x32_bf16 v[68:71], v[52:55], v[36:39], v[68:71]
    s_waitcnt lgkmcnt(7)
    v_mfma_f32_16x16x32_bf16 v[72:75], v[56:59], v[36:39], v[72:75]
    s_waitcnt lgkmcnt(5)
    v_mfma_f32_16x16x32_bf16 v[76:79], v[60:63], v[36:39], v[76:79]
    s_waitcnt lgkmcnt(3)
    v_mfma_f32_16x16x32_bf16 v[80:83], v[64:67], v[36:39], v[80:83]
    s_waitcnt lgkmcnt(2)
    v_mfma_f32_16x16x32_bf16 v[84:87], v[52:55], v[40:43], v[84:87]
    v_mfma_f32_16x16x32_bf16 v[88:91], v[56:59], v[40:43], v[88:91]
    v_mfma_f32_16x16x32_bf16 v[92:95], v[60:63], v[40:43], v[92:95]
    v_mfma_f32_16x16x32_bf16 v[96:99], v[64:67], v[40:43], v[96:99]
    s_waitcnt lgkmcnt(0)
    s_barrier
    v_mfma_f32_16x16x32_bf16 v[100:103], v[52:55], v[44:47], v[100:103]
    ds_read_b128 v[4:7], v132 offset:0
    ds_read_b64_tr_b16 v[20:21], v136 offset:0
    v_mfma_f32_16x16x32_bf16 v[104:107], v[56:59], v[44:47], v[104:107]
    ds_read_b64_tr_b16 v[22:23], v136 offset:1024
    ds_read_b64_tr_b16 v[24:25], v137 offset:0
    v_mfma_f32_16x16x32_bf16 v[108:111], v[60:63], v[44:47], v[108:111]
    ds_read_b64_tr_b16 v[26:27], v137 offset:1024
    ds_read_b64_tr_b16 v[28:29], v138 offset:0
    v_mfma_f32_16x16x32_bf16 v[112:115], v[64:67], v[44:47], v[112:115]
    ds_read_b64_tr_b16 v[30:31], v138 offset:1024
    ds_read_b64_tr_b16 v[32:33], v139 offset:0
    v_mfma_f32_16x16x32_bf16 v[116:119], v[52:55], v[48:51], v[116:119]
    ds_read_b64_tr_b16 v[34:35], v139 offset:1024
    v_mfma_f32_16x16x32_bf16 v[120:123], v[56:59], v[48:51], v[120:123]
    ds_read_b128 v[8:11], v132 offset:2048
    v_mfma_f32_16x16x32_bf16 v[124:127], v[60:63], v[48:51], v[124:127]
    ds_read_b128 v[12:15], v132 offset:4096
    s_sub_u32 s62, s62, 1
    v_mfma_f32_16x16x32_bf16 v[128:131], v[64:67], v[48:51], v[128:131]
    ds_read_b128 v[16:19], v132 offset:6144
    s_cbranch_scc0 L_glq
    s_cmp_eq_u32 s48, 0
    s_waitcnt lgkmcnt(9)
    v_mfma_f32_16x16x32_bf16 v[68:71], v[20:23], v[4:7], v[68:71]
    ds_read_b128 v[36:39], v133 offset:0
    ds_read_b64_tr_b16 v[52:53], v136 offset:8192
    s_waitcnt lgkmcnt(9)
    v_mfma_f32_16x16x32_bf16 v[72:75], v[24:27], v[4:7], v[72:75]
    ds_read_b64_tr_b16 v[54:55], v136 offset:9216
    ds_read_b64_tr_b16 v[56:57], v137 offset:8192
    s_waitcnt lgkmcnt(9)
    v_mfma_f32_16x16x32_bf16 v[76:79], v[28:31], v[4:7], v[76:79]
    ds_read_b64_tr_b16 v[58:59], v137 offset:9216
    ds_read_b64_tr_b16 v[60:61], v138 offset:8192
    s_waitcnt lgkmcnt(9)
    v_mfma_f32_16x16x32_bf16 v[80:83], v[32:35], v[4:7], v[80:83]
    ds_read_b64_tr_b16 v[62:63], v138 offset:9216
    ds_read_b64_tr_b16 v[64:65], v139 offset:8192
    s_waitcnt lgkmcnt(10)
    v_mfma_f32_16x16x32_bf16 v[84:87], v[20:23], v[8:11], v[84:87]
    ds_read_b64_tr_b16 v[66:67], v139 offset:9216
    ds_read_b128 v[40:43], v133 offset:2048
    v_mfma_f32_16x16x32_bf16 v[88:91], v[24:27], v[8:11], v[88:91]
    ds_read_b128 v[44:47], v133 offset:4096
    ds_read_b128 v[48:51], v133 offset:6144
    v_mfma_f32_16x16x32_bf16 v[92:95], v[28:31], v[8:11], v[92:95]
    v_mfma_f32_16x16x32_bf16 v[96:99], v[32:35], v[8:11], v[96:99]
    s_waitcnt lgkmcnt(9)
    v_mfma_f32_16x16x32_bf16 v[68:71], v[52:55], v[36:39], v[68:71]
    s_waitcnt lgkmcnt(7)
    v_mfma_f32_16x16x32_bf16 v[72:75], v[56:59], v[36:39], v[72:75]
    s_waitcnt lgkmcnt(5)
    v_mfma_f32_16x16x32_bf16 v[76:79], v[60:63], v[36:39], v[76:79]
    s_waitcnt lgkmcnt(3)
    v_mfma_f32_16x16x32_bf16 v[80:83], v[64:67], v[36:39], v[80:83]
    s_nop 0
    s_nop 0
    s_waitcnt lgkmcnt(2)
    v_mfma_f32_16x16x32_bf16 v[84:87], v[52:55], v[40:43], v[84:87]
    s_nop 0
    s_nop 0
    v_mfma_f32_16x16x32_bf16 v[88:91], v[56:59], v[40:43], v[88:91]
    s_nop 0
    s_nop 0
    v_mfma_f32_16x16x32_bf16 v[92:95], v[60:63], v[40:43], v[92:95]
    v_mul_f32 v68, s54, v68
    v_mul_f32 v69, s54, v69
    v_mfma_f32_16x16x32_bf16 v[96:99], v[64:67], v[40:43], v[96:99]
    v_mul_f32 v70, s54, v70
    v_mul_f32 v71, s54, v71
    v_mfma_f32_16x16x32_bf16 v[100:103], v[20:23], v[12:15], v[100:103]
    v_mul_f32 v72, s54, v72
    v_mul_f32 v73, s54, v73
    v_mfma_f32_16x16x32_bf16 v[104:107], v[24:27], v[12:15], v[104:107]
    v_mul_f32 v74, s54, v74
    v_mul_f32 v75, s54, v75
    v_mfma_f32_16x16x32_bf16 v[108:111], v[28:31], v[12:15], v[108:111]
    v_cvt_pk_bf16_f32 v68, v68, v69
    v_cvt_pk_bf16_f32 v69, v70, v71
    v_mfma_f32_16x16x32_bf16 v[112:115], v[32:35], v[12:15], v[112:115]
    v_cvt_pk_bf16_f32 v70, v72, v73
    v_cvt_pk_bf16_f32 v71, v74, v75
    s_waitcnt lgkmcnt(1)
    v_mfma_f32_16x16x32_bf16 v[100:103], v[52:55], v[44:47], v[100:103]
    buffer_store_dwordx4 v[68:71], v144, s[24:27], s60 offen offset:0 sc1
    v_mul_f32 v76, s54, v76
    v_mfma_f32_16x16x32_bf16 v[104:107], v[56:59], v[44:47], v[104:107]
    v_mul_f32 v77, s54, v77
    v_mul_f32 v78, s54, v78
    v_mfma_f32_16x16x32_bf16 v[108:111], v[60:63], v[44:47], v[108:111]
    v_mul_f32 v79, s54, v79
    v_mul_f32 v80, s54, v80
    v_mfma_f32_16x16x32_bf16 v[112:115], v[64:67], v[44:47], v[112:115]
    v_mul_f32 v81, s54, v81
    v_mul_f32 v82, s54, v82
    v_mfma_f32_16x16x32_bf16 v[116:119], v[20:23], v[16:19], v[116:119]
    v_mul_f32 v83, s54, v83
    v_cvt_pk_bf16_f32 v72, v76, v77
    v_mfma_f32_16x16x32_bf16 v[120:123], v[24:27], v[16:19], v[120:123]
    v_cvt_pk_bf16_f32 v73, v78, v79
    v_cvt_pk_bf16_f32 v74, v80, v81
    v_mfma_f32_16x16x32_bf16 v[124:127], v[28:31], v[16:19], v[124:127]
    v_cvt_pk_bf16_f32 v75, v82, v83
    buffer_store_dwordx4 v[72:75], v145, s[24:27], s60 offen offset:0 sc1
    v_mfma_f32_16x16x32_bf16 v[128:131], v[32:35], v[16:19], v[128:131]
    s_cbranch_scc1 L_s0
    buffer_store_dwordx2 v[72:73], v146, s[24:27], s60 offen offset:0 sc1
    buffer_store_dwordx2 v[74:75], v147, s[24:27], s60 offen offset:0 sc1
L_s0:
    v_mul_f32 v84, s54, v84
    s_waitcnt lgkmcnt(0)
    v_mfma_f32_16x16x32_bf16 v[116:119], v[52:55], v[48:51], v[116:119]
    v_mul_f32 v85, s54, v85
    v_mul_f32 v86, s54, v86
    v_mfma_f32_16x16x32_bf16 v[120:123], v[56:59], v[48:51], v[120:123]
    v_mul_f32 v87, s54, v87
    v_mul_f32 v88, s54, v88
    v_mfma_f32_16x16x32_bf16 v[124:127], v[60:63], v[48:51], v[124:127]
    v_mul_f32 v89, s54, v89
    v_mul_f32 v90, s54, v90
    v_mfma_f32_16x16x32_bf16 v[128:131], v[64:67], v[48:51], v[128:131]
    v_mul_f32 v91, s54, v91
    v_cvt_pk_bf16_f32 v84, v84, v85
    v_cvt_pk_bf16_f32 v85, v86, v87
    v_cvt_pk_bf16_f32 v86, v88, v89
    v_cvt_pk_bf16_f32 v87, v90, v91
    buffer_store_dwordx4 v[84:87], v144, s[24:27], s60 offen offset:256 sc1
    v_pk_mul_f32 v[92:93], v[92:93], s[54:55]
    v_pk_mul_f32 v[94:95], v[94:95], s[54:55]
    v_pk_mul_f32 v[96:97], v[96:97], s[54:55]
    v_pk_mul_f32 v[98:99], v[98:99], s[54:55]
    v_cvt_pk_bf16_f32 v88, v92, v93
    v_cvt_pk_bf16_f32 v89, v94, v95
    v_cvt_pk_bf16_f32 v90, v96, v97
    v_cvt_pk_bf16_f32 v91, v98, v99
    buffer_store_dwordx4 v[88:91], v145, s[24:27], s60 offen offset:256 sc1
    s_cbranch_scc1 L_s1
    buffer_store_dwordx2 v[88:89], v146, s[24:27], s60 offen offset:128 sc1
    buffer_store_dwordx2 v[90:91], v147, s[24:27], s60 offen offset:128 sc1
L_s1:
    v_pk_mul_f32 v[100:101], v[100:101], s[54:55]
    v_pk_mul_f32 v[102:103], v[102:103], s[54:55]
    v_pk_mul_f32 v[104:105], v[104:105], s[54:55]
    v_pk_mul_f32 v[106:107], v[106:107], s[54:55]
    v_cvt_pk_bf16_f32 v100, v100, v101
    v_cvt_pk_bf16_f32 v101, v102, v103
    v_cvt_pk_bf16_f32 v102, v104, v105
    v_cvt_pk_bf16_f32 v103, v106, v107
    buffer_store_dwordx4 v[100:103], v144, s[24:27], s60 offen offset:1024 sc1
    v_pk_mul_f32 v[108:109], v[108:109], s[54:55]
    v_pk_mul_f32 v[110:111], v[110:111], s[54:55]
    v_pk_mul_f32 v[112:113], v[112:113], s[54:55]
    v_pk_mul_f32 v[114:115], v[114:115], s[54:55]
    v_cvt_pk_bf16_f32 v104, v108, v109
    v_cvt_pk_bf16_f32 v105, v110, v111
    v_cvt_pk_bf16_f32 v106, v112, v113
    v_cvt_pk_bf16_f32 v107, v114, v115
    buffer_store_dwordx4 v[104:107], v145, s[24:27], s60 offen offset:1024 sc1
    s_cbranch_scc1 L_s2
    buffer_store_dwordx2 v[104:105], v146, s[24:27], s60 offen offset:256 sc1
    buffer_store_dwordx2 v[106:107], v147, s[24:27], s60 offen offset:256 sc1
L_s2:
    v_pk_mul_f32 v[116:117], v[116:117], s[54:55]
    v_pk_mul_f32 v[118:119], v[118:119], s[54:55]
    v_pk_mul_f32 v[120:121], v[120:121], s[54:55]
    v_pk_mul_f32 v[122:123], v[122:123], s[54:55]
    v_cvt_pk_bf16_f32 v116, v116, v117
    v_cvt_pk_bf16_f32 v117, v118, v119
    v_cvt_pk_bf16_f32 v118, v120, v121
    v_cvt_pk_bf16_f32 v119, v122, v123
    buffer_store_dwordx4 v[116:119], v144, s[24:27], s60 offen offset:1280 sc1
    v_pk_mul_f32 v[124:125], v[124:125], s[54:55]
    v_pk_mul_f32 v[126:127], v[126:127], s[54:55]
    v_pk_mul_f32 v[128:129], v[128:129], s[54:55]
    v_pk_mul_f32 v[130:131], v[130:131], s[54:55]
    v_cvt_pk_bf16_f32 v120, v124, v125
    v_cvt_pk_bf16_f32 v121, v126, v127
    v_cvt_pk_bf16_f32 v122, v128, v129
    v_cvt_pk_bf16_f32 v123, v130, v131
    buffer_store_dwordx4 v[120:123], v145, s[24:27], s60 offen offset:1280 sc1
    s_cbranch_scc1 L_s3
    buffer_store_dwordx2 v[120:121], v146, s[24:27], s60 offen offset:384 sc1
    buffer_store_dwordx2 v[122:123], v147, s[24:27], s60 offen offset:384 sc1
L_s3:
    s_waitcnt vmcnt(0)
    s_branch L_b1
.p2align 12
L_vpath:
L_pad1:
    s_cbranch_execz L_padret
    s_mul_i32 s52, s47, 2560
    s_add_u32 s60, s60, s52
    s_add_u32 s60, s60, 5120
    s_lshl_b32 s52, s50, 7
    s_lshl_b32 s53, s48, 6
    s_add_u32 s52, s52, s53
    v_add3_u32 v152, s52, v2, 0
    v_mul_u32_u24 v153, 3277, v152
    v_lshrrev_b32 v153, 16, v153
    v_sub_u32 v154, v3, v153
    v_mad_i32_i24 v152, v154, 20, v152
    v_mul_lo_u32 v153, v153, s61
    v_lshl_add_u32 v144, v152, 4, v153
    v_add3_u32 v152, s52, v2, 16
    v_mul_u32_u24 v153, 3277, v152
    v_lshrrev_b32 v153, 16, v153
    v_sub_u32 v154, v3, v153
    v_mad_i32_i24 v152, v154, 20, v152
    v_mul_lo_u32 v153, v153, s61
    v_lshl_add_u32 v145, v152, 4, v153
    v_add3_u32 v152, s52, v2, 32
    v_mul_u32_u24 v153, 3277, v152
    v_lshrrev_b32 v153, 16, v153
    v_sub_u32 v154, v3, v153
    v_mad_i32_i24 v152, v154, 20, v152
    v_mul_lo_u32 v153, v153, s61
    v_lshl_add_u32 v146, v152, 4, v153
    v_add3_u32 v152, s52, v2, 48
    v_mul_u32_u24 v153, 3277, v152
    v_lshrrev_b32 v153, 16, v153
    v_sub_u32 v154, v3, v153
    v_mad_i32_i24 v152, v154, 20, v152
    v_mul_lo_u32 v153, v153, s61
    v_lshl_add_u32 v147, v152, 4, v153
    s_mov_b32 s62, 2
    s_waitcnt lgkmcnt(0)
    s_barrier
    ds_read_b64_tr_b16 v[20:21], v136 offset:0
    ds_read_b64_tr_b16 v[22:23], v136 offset:1024
    ds_read_b128 v[4:7], v132 offset:0
    ds_read_b128 v[8:11], v132 offset:2048
    ds_read_b128 v[12:15], v132 offset:4096
    ds_read_b128 v[16:19], v132 offset:6144
    ds_read_b64_tr_b16 v[24:25], v137 offset:0
    ds_read_b64_tr_b16 v[26:27], v137 offset:1024
    ds_read_b64_tr_b16 v[28:29], v138 offset:0
    ds_read_b64_tr_b16 v[30:31], v138 offset:1024
    ds_read_b64_tr_b16 v[32:33], v139 offset:0
    ds_read_b64_tr_b16 v[34:35], v139 offset:1024
L_glv:
    s_waitcnt lgkmcnt(9)
    v_mfma_f32_16x16x32_bf16 v[68:71], v[4:7], v[20:23], v[68:71]
    ds_read_b64_tr_b16 v[52:53], v136 offset:8192
    s_waitcnt lgkmcnt(9)
    v_mfma_f32_16x16x32_bf16 v[72:75], v[8:11], v[20:23], v[72:75]
    ds_read_b64_tr_b16 v[54:55], v136 offset:9216
    s_waitcnt lgkmcnt(9)
    v_mfma_f32_16x16x32_bf16 v[76:79], v[12:15], v[20:23], v[76:79]
    ds_read_b128 v[36:39], v133 offset:0
    s_waitcnt lgkmcnt(9)
    v_mfma_f32_16x16x32_bf16 v[80:83], v[16:19], v[20:23], v[80:83]
    ds_read_b128 v[40:43], v133 offset:2048
    s_waitcnt lgkmcnt(8)
    v_mfma_f32_16x16x32_bf16 v[84:87], v[4:7], v[24:27], v[84:87]
    ds_read_b128 v[44:47], v133 offset:4096
    v_mfma_f32_16x16x32_bf16 v[88:91], v[8:11], v[24:27], v[88:91]
    ds_read_b128 v[48:51], v133 offset:6144
    v_mfma_f32_16x16x32_bf16 v[92:95], v[12:15], v[24:27], v[92:95]
    ds_read_b64_tr_b16 v[56:57], v137 offset:8192
    v_mfma_f32_16x16x32_bf16 v[96:99], v[16:19], v[24:27], v[96:99]
    ds_read_b64_tr_b16 v[58:59], v137 offset:9216
    s_waitcnt lgkmcnt(10)
    v_mfma_f32_16x16x32_bf16 v[100:103], v[4:7], v[28:31], v[100:103]
    ds_read_b64_tr_b16 v[60:61], v138 offset:8192
    v_mfma_f32_16x16x32_bf16 v[104:107], v[8:11], v[28:31], v[104:107]
    ds_read_b64_tr_b16 v[62:63], v138 offset:9216
    v_mfma_f32_16x16x32_bf16 v[108:111], v[12:15], v[28:31], v[108:111]
    ds_read_b64_tr_b16 v[64:65], v139 offset:8192
    v_mfma_f32_16x16x32_bf16 v[112:115], v[16:19], v[28:31], v[112:115]
    ds_read_b64_tr_b16 v[66:67], v139 offset:9216
    s_waitcnt lgkmcnt(12)
    v_mfma_f32_16x16x32_bf16 v[116:119], v[4:7], v[32:35], v[116:119]
    v_mfma_f32_16x16x32_bf16 v[120:123], v[8:11], v[32:35], v[120:123]
    v_mfma_f32_16x16x32_bf16 v[124:127], v[12:15], v[32:35], v[124:127]
    v_mfma_f32_16x16x32_bf16 v[128:131], v[16:19], v[32:35], v[128:131]
    s_waitcnt lgkmcnt(9)
    v_mfma_f32_16x16x32_bf16 v[68:71], v[36:39], v[52:55], v[68:71]
    s_waitcnt lgkmcnt(8)
    v_mfma_f32_16x16x32_bf16 v[72:75], v[40:43], v[52:55], v[72:75]
    s_waitcnt lgkmcnt(7)
    v_mfma_f32_16x16x32_bf16 v[76:79], v[44:47], v[52:55], v[76:79]
    s_waitcnt lgkmcnt(6)
    v_mfma_f32_16x16x32_bf16 v[80:83], v[48:51], v[52:55], v[80:83]
    s_waitcnt lgkmcnt(4)
    v_mfma_f32_16x16x32_bf16 v[84:87], v[36:39], v[56:59], v[84:87]
    v_mfma_f32_16x16x32_bf16 v[88:91], v[40:43], v[56:59], v[88:91]
    v_mfma_f32_16x16x32_bf16 v[92:95], v[44:47], v[56:59], v[92:95]
    v_mfma_f32_16x16x32_bf16 v[96:99], v[48:51], v[56:59], v[96:99]
    s_waitcnt lgkmcnt(0)
    s_barrier
    v_mfma_f32_16x16x32_bf16 v[100:103], v[36:39], v[60:63], v[100:103]
    ds_read_b64_tr_b16 v[20:21], v136 offset:32768
    ds_read_b64_tr_b16 v[22:23], v136 offset:33792
    v_mfma_f32_16x16x32_bf16 v[104:107], v[40:43], v[60:63], v[104:107]
    ds_read_b128 v[4:7], v132 offset:32768
    ds_read_b128 v[8:11], v132 offset:34816
    v_mfma_f32_16x16x32_bf16 v[108:111], v[44:47], v[60:63], v[108:111]
    ds_read_b128 v[12:15], v132 offset:36864
    ds_read_b128 v[16:19], v132 offset:38912
    v_mfma_f32_16x16x32_bf16 v[112:115], v[48:51], v[60:63], v[112:115]
    ds_read_b64_tr_b16 v[24:25], v137 offset:32768
    ds_read_b64_tr_b16 v[26:27], v137 offset:33792
    v_mfma_f32_16x16x32_bf16 v[116:119], v[36:39], v[64:67], v[116:119]
    ds_read_b64_tr_b16 v[28:29], v138 offset:32768
    v_mfma_f32_16x16x32_bf16 v[120:123], v[40:43], v[64:67], v[120:123]
    ds_read_b64_tr_b16 v[30:31], v138 offset:33792
    v_mfma_f32_16x16x32_bf16 v[124:127], v[44:47], v[64:67], v[124:127]
    ds_read_b64_tr_b16 v[32:33], v139 offset:32768
    v_mfma_f32_16x16x32_bf16 v[128:131], v[48:51], v[64:67], v[128:131]
    ds_read_b64_tr_b16 v[34:35], v139 offset:33792
    s_waitcnt lgkmcnt(9)
    v_mfma_f32_16x16x32_bf16 v[68:71], v[4:7], v[20:23], v[68:71]
    ds_read_b64_tr_b16 v[52:53], v136 offset:40960
    s_waitcnt lgkmcnt(9)
    v_mfma_f32_16x16x32_bf16 v[72:75], v[8:11], v[20:23], v[72:75]
    ds_read_b64_tr_b16 v[54:55], v136 offset:41984
    s_waitcnt lgkmcnt(9)
    v_mfma_f32_16x16x32_bf16 v[76:79], v[12:15], v[20:23], v[76:79]
    ds_read_b128 v[36:39], v133 offset:32768
    s_waitcnt lgkmcnt(9)
    v_mfma_f32_16x16x32_bf16 v[80:83], v[16:19], v[20:23], v[80:83]
    ds_read_b128 v[40:43], v133 offset:34816
    s_waitcnt lgkmcnt(8)
    v_mfma_f32_16x16x32_bf16 v[84:87], v[4:7], v[24:27], v[84:87]
    ds_read_b128 v[44:47], v133 offset:36864
    v_mfma_f32_16x16x32_bf16 v[88:91], v[8:11], v[24:27], v[88:91]
    ds_read_b128 v[48:51], v133 offset:38912
    v_mfma_f32_16x16x32_bf16 v[92:95], v[12:15], v[24:27], v[92:95]
    ds_read_b64_tr_b16 v[56:57], v137 offset:40960
    v_mfma_f32_16x16x32_bf16 v[96:99], v[16:19], v[24:27], v[96:99]
    ds_read_b64_tr_b16 v[58:59], v137 offset:41984
    s_waitcnt lgkmcnt(10)
    v_mfma_f32_16x16x32_bf16 v[100:103], v[4:7], v[28:31], v[100:103]
    ds_read_b64_tr_b16 v[60:61], v138 offset:40960
    v_mfma_f32_16x16x32_bf16 v[104:107], v[8:11], v[28:31], v[104:107]
    ds_read_b64_tr_b16 v[62:63], v138 offset:41984
    v_mfma_f32_16x16x32_bf16 v[108:111], v[12:15], v[28:31], v[108:111]
    ds_read_b64_tr_b16 v[64:65], v139 offset:40960
    v_mfma_f32_16x16x32_bf16 v[112:115], v[16:19], v[28:31], v[112:115]
    ds_read_b64_tr_b16 v[66:67], v139 offset:41984
    s_waitcnt lgkmcnt(12)
    v_mfma_f32_16x16x32_bf16 v[116:119], v[4:7], v[32:35], v[116:119]
    v_mfma_f32_16x16x32_bf16 v[120:123], v[8:11], v[32:35], v[120:123]
    v_mfma_f32_16x16x32_bf16 v[124:127], v[12:15], v[32:35], v[124:127]
    v_mfma_f32_16x16x32_bf16 v[128:131], v[16:19], v[32:35], v[128:131]
    s_waitcnt lgkmcnt(9)
    v_mfma_f32_16x16x32_bf16 v[68:71], v[36:39], v[52:55], v[68:71]
    s_waitcnt lgkmcnt(8)
    v_mfma_f32_16x16x32_bf16 v[72:75], v[40:43], v[52:55], v[72:75]
    s_waitcnt lgkmcnt(7)
    v_mfma_f32_16x16x32_bf16 v[76:79], v[44:47], v[52:55], v[76:79]
    s_waitcnt lgkmcnt(6)
    v_mfma_f32_16x16x32_bf16 v[80:83], v[48:51], v[52:55], v[80:83]
    s_waitcnt lgkmcnt(4)
    v_mfma_f32_16x16x32_bf16 v[84:87], v[36:39], v[56:59], v[84:87]
    v_mfma_f32_16x16x32_bf16 v[88:91], v[40:43], v[56:59], v[88:91]
    v_mfma_f32_16x16x32_bf16 v[92:95], v[44:47], v[56:59], v[92:95]
    v_mfma_f32_16x16x32_bf16 v[96:99], v[48:51], v[56:59], v[96:99]
    s_waitcnt lgkmcnt(0)
    s_barrier
    v_mfma_f32_16x16x32_bf16 v[100:103], v[36:39], v[60:63], v[100:103]
    ds_read_b64_tr_b16 v[20:21], v140 offset:0
    ds_read_b64_tr_b16 v[22:23], v140 offset:1024
    v_mfma_f32_16x16x32_bf16 v[104:107], v[40:43], v[60:63], v[104:107]
    ds_read_b128 v[4:7], v134 offset:0
    ds_read_b128 v[8:11], v134 offset:2048
    v_mfma_f32_16x16x32_bf16 v[108:111], v[44:47], v[60:63], v[108:111]
    ds_read_b128 v[12:15], v134 offset:4096
    ds_read_b128 v[16:19], v134 offset:6144
    v_mfma_f32_16x16x32_bf16 v[112:115], v[48:51], v[60:63], v[112:115]
    ds_read_b64_tr_b16 v[24:25], v141 offset:0
    ds_read_b64_tr_b16 v[26:27], v141 offset:1024
    v_mfma_f32_16x16x32_bf16 v[116:119], v[36:39], v[64:67], v[116:119]
    ds_read_b64_tr_b16 v[28:29], v142 offset:0
    v_mfma_f32_16x16x32_bf16 v[120:123], v[40:43], v[64:67], v[120:123]
    ds_read_b64_tr_b16 v[30:31], v142 offset:1024
    v_mfma_f32_16x16x32_bf16 v[124:127], v[44:47], v[64:67], v[124:127]
    ds_read_b64_tr_b16 v[32:33], v143 offset:0
    v_mfma_f32_16x16x32_bf16 v[128:131], v[48:51], v[64:67], v[128:131]
    ds_read_b64_tr_b16 v[34:35], v143 offset:1024
    s_waitcnt lgkmcnt(9)
    v_mfma_f32_16x16x32_bf16 v[68:71], v[4:7], v[20:23], v[68:71]
    ds_read_b64_tr_b16 v[52:53], v140 offset:8192
    s_waitcnt lgkmcnt(9)
    v_mfma_f32_16x16x32_bf16 v[72:75], v[8:11], v[20:23], v[72:75]
    ds_read_b64_tr_b16 v[54:55], v140 offset:9216
    s_waitcnt lgkmcnt(9)
    v_mfma_f32_16x16x32_bf16 v[76:79], v[12:15], v[20:23], v[76:79]
    ds_read_b128 v[36:39], v135 offset:0
    s_waitcnt lgkmcnt(9)
    v_mfma_f32_16x16x32_bf16 v[80:83], v[16:19], v[20:23], v[80:83]
    ds_read_b128 v[40:43], v135 offset:2048
    s_waitcnt lgkmcnt(8)
    v_mfma_f32_16x16x32_bf16 v[84:87], v[4:7], v[24:27], v[84:87]
    ds_read_b128 v[44:47], v135 offset:4096
    v_mfma_f32_16x16x32_bf16 v[88:91], v[8:11], v[24:27], v[88:91]
    ds_read_b128 v[48:51], v135 offset:6144
    v_mfma_f32_16x16x32_bf16 v[92:95], v[12:15], v[24:27], v[92:95]
    ds_read_b64_tr_b16 v[56:57], v141 offset:8192
    v_mfma_f32_16x16x32_bf16 v[96:99], v[16:19], v[24:27], v[96:99]
    ds_read_b64_tr_b16 v[58:59], v141 offset:9216
    s_waitcnt lgkmcnt(10)
    v_mfma_f32_16x16x32_bf16 v[100:103], v[4:7], v[28:31], v[100:103]
    ds_read_b64_tr_b16 v[60:61], v142 offset:8192
    v_mfma_f32_16x16x32_bf16 v[104:107], v[8:11], v[28:31], v[104:107]
    ds_read_b64_tr_b16 v[62:63], v142 offset:9216
    v_mfma_f32_16x16x32_bf16 v[108:111], v[12:15], v[28:31], v[108:111]
    ds_read_b64_tr_b16 v[64:65], v143 offset:8192
    v_mfma_f32_16x16x32_bf16 v[112:115], v[16:19], v[28:31], v[112:115]
    ds_read_b64_tr_b16 v[66:67], v143 offset:9216
    s_waitcnt lgkmcnt(12)
    v_mfma_f32_16x16x32_bf16 v[116:119], v[4:7], v[32:35], v[116:119]
    v_mfma_f32_16x16x32_bf16 v[120:123], v[8:11], v[32:35], v[120:123]
    v_mfma_f32_16x16x32_bf16 v[124:127], v[12:15], v[32:35], v[124:127]
    v_mfma_f32_16x16x32_bf16 v[128:131], v[16:19], v[32:35], v[128:131]
    s_waitcnt lgkmcnt(9)
    v_mfma_f32_16x16x32_bf16 v[68:71], v[36:39], v[52:55], v[68:71]
    s_waitcnt lgkmcnt(8)
    v_mfma_f32_16x16x32_bf16 v[72:75], v[40:43], v[52:55], v[72:75]
    s_waitcnt lgkmcnt(7)
    v_mfma_f32_16x16x32_bf16 v[76:79], v[44:47], v[52:55], v[76:79]
    s_waitcnt lgkmcnt(6)
    v_mfma_f32_16x16x32_bf16 v[80:83], v[48:51], v[52:55], v[80:83]
    s_waitcnt lgkmcnt(4)
    v_mfma_f32_16x16x32_bf16 v[84:87], v[36:39], v[56:59], v[84:87]
    v_mfma_f32_16x16x32_bf16 v[88:91], v[40:43], v[56:59], v[88:91]
    v_mfma_f32_16x16x32_bf16 v[92:95], v[44:47], v[56:59], v[92:95]
    v_mfma_f32_16x16x32_bf16 v[96:99], v[48:51], v[56:59], v[96:99]
    s_waitcnt lgkmcnt(0)
    s_barrier
    v_mfma_f32_16x16x32_bf16 v[100:103], v[36:39], v[60:63], v[100:103]
    ds_read_b64_tr_b16 v[20:21], v136 offset:0
    ds_read_b64_tr_b16 v[22:23], v136 offset:1024
    v_mfma_f32_16x16x32_bf16 v[104:107], v[40:43], v[60:63], v[104:107]
    ds_read_b128 v[4:7], v132 offset:0
    ds_read_b128 v[8:11], v132 offset:2048
    v_mfma_f32_16x16x32_bf16 v[108:111], v[44:47], v[60:63], v[108:111]
    ds_read_b128 v[12:15], v132 offset:4096
    ds_read_b128 v[16:19], v132 offset:6144
    v_mfma_f32_16x16x32_bf16 v[112:115], v[48:51], v[60:63], v[112:115]
    ds_read_b64_tr_b16 v[24:25], v137 offset:0
    ds_read_b64_tr_b16 v[26:27], v137 offset:1024
    v_mfma_f32_16x16x32_bf16 v[116:119], v[36:39], v[64:67], v[116:119]
    ds_read_b64_tr_b16 v[28:29], v138 offset:0
    v_mfma_f32_16x16x32_bf16 v[120:123], v[40:43], v[64:67], v[120:123]
    ds_read_b64_tr_b16 v[30:31], v138 offset:1024
    v_mfma_f32_16x16x32_bf16 v[124:127], v[44:47], v[64:67], v[124:127]
    ds_read_b64_tr_b16 v[32:33], v139 offset:0
    s_sub_u32 s62, s62, 1
    v_mfma_f32_16x16x32_bf16 v[128:131], v[48:51], v[64:67], v[128:131]
    ds_read_b64_tr_b16 v[34:35], v139 offset:1024
    s_cbranch_scc0 L_glv
    s_cmp_eq_u32 s48, 0
    s_waitcnt lgkmcnt(9)
    v_mfma_f32_16x16x32_bf16 v[68:71], v[4:7], v[20:23], v[68:71]
    ds_read_b64_tr_b16 v[52:53], v136 offset:8192
    ds_read_b64_tr_b16 v[54:55], v136 offset:9216
    s_waitcnt lgkmcnt(10)
    v_mfma_f32_16x16x32_bf16 v[72:75], v[8:11], v[20:23], v[72:75]
    ds_read_b128 v[36:39], v133 offset:0
    ds_read_b128 v[40:43], v133 offset:2048
    s_waitcnt lgkmcnt(11)
    v_mfma_f32_16x16x32_bf16 v[76:79], v[12:15], v[20:23], v[76:79]
    ds_read_b128 v[44:47], v133 offset:4096
    ds_read_b128 v[48:51], v133 offset:6144
    s_waitcnt lgkmcnt(12)
    v_mfma_f32_16x16x32_bf16 v[80:83], v[16:19], v[20:23], v[80:83]
    ds_read_b64_tr_b16 v[56:57], v137 offset:8192
    ds_read_b64_tr_b16 v[58:59], v137 offset:9216
    s_waitcnt lgkmcnt(12)
    v_mfma_f32_16x16x32_bf16 v[84:87], v[4:7], v[24:27], v[84:87]
    ds_read_b64_tr_b16 v[60:61], v138 offset:8192
    ds_read_b64_tr_b16 v[62:63], v138 offset:9216
    v_mfma_f32_16x16x32_bf16 v[88:91], v[8:11], v[24:27], v[88:91]
    ds_read_b64_tr_b16 v[64:65], v139 offset:8192
    ds_read_b64_tr_b16 v[66:67], v139 offset:9216
    v_mfma_f32_16x16x32_bf16 v[92:95], v[12:15], v[24:27], v[92:95]
    v_mfma_f32_16x16x32_bf16 v[96:99], v[16:19], v[24:27], v[96:99]
    s_waitcnt lgkmcnt(9)
    v_mfma_f32_16x16x32_bf16 v[68:71], v[36:39], v[52:55], v[68:71]
    s_waitcnt lgkmcnt(8)
    v_mfma_f32_16x16x32_bf16 v[72:75], v[40:43], v[52:55], v[72:75]
    s_waitcnt lgkmcnt(7)
    v_mfma_f32_16x16x32_bf16 v[76:79], v[44:47], v[52:55], v[76:79]
    s_waitcnt lgkmcnt(6)
    v_mfma_f32_16x16x32_bf16 v[80:83], v[48:51], v[52:55], v[80:83]
    s_nop 0
    s_nop 0
    s_waitcnt lgkmcnt(4)
    v_mfma_f32_16x16x32_bf16 v[84:87], v[36:39], v[56:59], v[84:87]
    s_nop 0
    s_nop 0
    v_mfma_f32_16x16x32_bf16 v[88:91], v[40:43], v[56:59], v[88:91]
    s_nop 0
    s_nop 0
    v_mfma_f32_16x16x32_bf16 v[92:95], v[44:47], v[56:59], v[92:95]
    v_cvt_pk_bf16_f32 v68, v68, v69
    v_cvt_pk_bf16_f32 v69, v70, v71
    v_mfma_f32_16x16x32_bf16 v[96:99], v[48:51], v[56:59], v[96:99]
    v_cvt_pk_bf16_f32 v70, v72, v73
    v_cvt_pk_bf16_f32 v71, v74, v75
    v_mfma_f32_16x16x32_bf16 v[100:103], v[4:7], v[28:31], v[100:103]
    buffer_store_dwordx4 v[68:71], v144, s[24:27], s60 offen offset:0 sc1
    v_cvt_pk_bf16_f32 v72, v76, v77
    v_mfma_f32_16x16x32_bf16 v[104:107], v[8:11], v[28:31], v[104:107]
    v_cvt_pk_bf16_f32 v73, v78, v79
    v_cvt_pk_bf16_f32 v74, v80, v81
    v_mfma_f32_16x16x32_bf16 v[108:111], v[12:15], v[28:31], v[108:111]
    v_cvt_pk_bf16_f32 v75, v82, v83
    buffer_store_dwordx4 v[72:75], v144, s[24:27], s60 offen offset:1280 sc1
    v_mfma_f32_16x16x32_bf16 v[112:115], v[16:19], v[28:31], v[112:115]
    v_cvt_pk_bf16_f32 v84, v84, v85
    v_cvt_pk_bf16_f32 v85, v86, v87
    s_waitcnt lgkmcnt(2)
    v_mfma_f32_16x16x32_bf16 v[100:103], v[36:39], v[60:63], v[100:103]
    v_cvt_pk_bf16_f32 v86, v88, v89
    v_cvt_pk_bf16_f32 v87, v90, v91
    v_mfma_f32_16x16x32_bf16 v[104:107], v[40:43], v[60:63], v[104:107]
    buffer_store_dwordx4 v[84:87], v145, s[24:27], s60 offen offset:0 sc1
    v_cvt_pk_bf16_f32 v88, v92, v93
    v_mfma_f32_16x16x32_bf16 v[108:111], v[44:47], v[60:63], v[108:111]
    v_cvt_pk_bf16_f32 v89, v94, v95
    v_cvt_pk_bf16_f32 v90, v96, v97
    v_mfma_f32_16x16x32_bf16 v[112:115], v[48:51], v[60:63], v[112:115]
    v_cvt_pk_bf16_f32 v91, v98, v99
    buffer_store_dwordx4 v[88:91], v145, s[24:27], s60 offen offset:1280 sc1
    v_mfma_f32_16x16x32_bf16 v[116:119], v[4:7], v[32:35], v[116:119]
    s_nop 0
    s_nop 0
    v_mfma_f32_16x16x32_bf16 v[120:123], v[8:11], v[32:35], v[120:123]
    s_nop 0
    s_nop 0
    v_mfma_f32_16x16x32_bf16 v[124:127], v[12:15], v[32:35], v[124:127]
    v_cvt_pk_bf16_f32 v100, v100, v101
    v_cvt_pk_bf16_f32 v101, v102, v103
    v_mfma_f32_16x16x32_bf16 v[128:131], v[16:19], v[32:35], v[128:131]
    v_cvt_pk_bf16_f32 v102, v104, v105
    v_cvt_pk_bf16_f32 v103, v106, v107
    s_waitcnt lgkmcnt(0)
    v_mfma_f32_16x16x32_bf16 v[116:119], v[36:39], v[64:67], v[116:119]
    buffer_store_dwordx4 v[100:103], v146, s[24:27], s60 offen offset:0 sc1
    v_cvt_pk_bf16_f32 v104, v108, v109
    v_mfma_f32_16x16x32_bf16 v[120:123], v[40:43], v[64:67], v[120:123]
    v_cvt_pk_bf16_f32 v105, v110, v111
    v_cvt_pk_bf16_f32 v106, v112, v113
    v_mfma_f32_16x16x32_bf16 v[124:127], v[44:47], v[64:67], v[124:127]
    v_cvt_pk_bf16_f32 v107, v114, v115
    buffer_store_dwordx4 v[104:107], v146, s[24:27], s60 offen offset:1280 sc1
    v_mfma_f32_16x16x32_bf16 v[128:131], v[48:51], v[64:67], v[128:131]
    s_nop 0
    s_nop 0
    s_nop 0
    s_nop 0
    s_nop 0
    s_nop 0
    s_nop 0
    s_nop 0
    v_cvt_pk_bf16_f32 v116, v116, v117
    v_cvt_pk_bf16_f32 v117, v118, v119
    v_cvt_pk_bf16_f32 v118, v120, v121
    v_cvt_pk_bf16_f32 v119, v122, v123
    buffer_store_dwordx4 v[116:119], v147, s[24:27], s60 offen offset:0 sc1
    v_cvt_pk_bf16_f32 v120, v124, v125
    v_cvt_pk_bf16_f32 v121, v126, v127
    v_cvt_pk_bf16_f32 v122, v128, v129
    v_cvt_pk_bf16_f32 v123, v130, v131
    buffer_store_dwordx4 v[120:123], v147, s[24:27], s60 offen offset:1280 sc1
    s_waitcnt vmcnt(0)
    s_branch L_b1
.p2align 12
L_woimg:
    s_load_dwordx2 s[28:29], s[0:1], 16
    s_mov_b32 s30, 819200
    s_mov_b32 s31, s27
    s_mov_b32 s45, s40
    v_lshlrev_b32 v1, 4, v0
    s_mov_b64 exec, 0
    s_nop 0
    s_cmp_eq_u32 s40, 0
    s_cbranch_scc1 L_pad0
    s_cmp_eq_u32 s40, 1
    s_cbranch_scc1 L_pad1
    s_cmp_eq_u32 s40, 2
    s_cbranch_scc1 L_pad2
    s_cmp_eq_u32 s40, 3
    s_cbranch_scc1 L_pad4
    s_cmp_eq_u32 s40, 4
    s_cbranch_scc1 L_pad5
    s_cmp_eq_u32 s40, 5
    s_cbranch_scc1 L_pad7
    s_cmp_eq_u32 s40, 6
    s_cbranch_scc1 L_pad0
    s_cmp_eq_u32 s40, 7
    s_cbranch_scc1 L_pad1
L_padret:
    s_mov_b64 exec, -1
    s_barrier
L_wo_loop:
    s_sub_u32 s46, s2, 240
    s_mul_i32 s46, s46, 10
    s_add_u32 s46, s46, s45
    s_mul_i32 s47, s46, 205
    s_lshr_b32 s47, s47, 10
    s_mul_i32 s49, s47, 5
    s_sub_u32 s49, s46, s49
    s_lshr_b32 s48, s47, 2
    s_and_b32 s47, s47, 3
    s_mul_i32 s50, s49, 40
    s_cmp_lt_u32 s49, 4
    s_cselect_b32 s50, s50, 16
    s_cselect_b32 s52, 20, 80
    s_cselect_b32 s53, 4, 40
    s_cselect_b32 s58, 8, 20
    s_mul_i32 s51, s47, 160
    s_add_u32 s50, s50, s51
    s_mul_i32 s50, s50, 1280
    s_mul_i32 s58, s58, 1280
    s_mov_b32 s54, 0
    s_movk_i32 s55, 1280
    s_movk_i32 s56, 2560
    s_movk_i32 s57, 3840
    s_add_u32 s59, s58, s55
    s_add_u32 s60, s58, s56
    s_add_u32 s61, s58, s57
    s_mul_i32 s51, s48, 160
    s_add_u32 s50, s50, s51
    v_lshrrev_b32 v2, 5, v0
    v_mul_u32_u24 v2, s52, v2
    v_bfe_u32 v3, v0, 4, 1
    v_mad_u32_u24 v2, v3, s53, v2
    v_mul_u32_u24 v2, 1280, v2
    v_add_u32 v2, s50, v2
    v_and_b32 v3, 15, v0
    v_lshl_add_u32 v3, v3, 1, v2
    v_and_b32 v4, 12, v0
    v_lshl_add_u32 v2, v4, 1, v3
    s_and_b32 s51, s48, 1
    s_lshl_b32 s52, s51, 5
    s_lshl_b32 s51, s51, 7
    v_add_u32 v2, s52, v2
    v_subrev_u32 v3, s51, v3
    s_waitcnt lgkmcnt(0)
    buffer_load_ushort v8, v2, s[28:31], s54 offen offset:0
    buffer_load_ushort v9, v2, s[28:31], s55 offen offset:0
    buffer_load_ushort v10, v2, s[28:31], s56 offen offset:0
    buffer_load_ushort v11, v2, s[28:31], s57 offen offset:0
    buffer_load_ushort v12, v2, s[28:31], s58 offen offset:0
    buffer_load_ushort v13, v2, s[28:31], s59 offen offset:0
    buffer_load_ushort v14, v2, s[28:31], s60 offen offset:0
    buffer_load_ushort v15, v2, s[28:31], s61 offen offset:0
    buffer_load_ushort v16, v2, s[28:31], s54 offen offset:8
    buffer_load_ushort v17, v2, s[28:31], s55 offen offset:8
    buffer_load_ushort v18, v2, s[28:31], s56 offen offset:8
    buffer_load_ushort v19, v2, s[28:31], s57 offen offset:8
    buffer_load_ushort v20, v2, s[28:31], s58 offen offset:8
    buffer_load_ushort v21, v2, s[28:31], s59 offen offset:8
    buffer_load_ushort v22, v2, s[28:31], s60 offen offset:8
    buffer_load_ushort v23, v2, s[28:31], s61 offen offset:8
    buffer_load_ushort v24, v2, s[28:31], s54 offen offset:64
    buffer_load_ushort v25, v2, s[28:31], s55 offen offset:64
    buffer_load_ushort v26, v2, s[28:31], s56 offen offset:64
    buffer_load_ushort v27, v2, s[28:31], s57 offen offset:64
    buffer_load_ushort v28, v2, s[28:31], s58 offen offset:64
    buffer_load_ushort v29, v2, s[28:31], s59 offen offset:64
    buffer_load_ushort v30, v2, s[28:31], s60 offen offset:64
    buffer_load_ushort v31, v2, s[28:31], s61 offen offset:64
    buffer_load_ushort v32, v2, s[28:31], s54 offen offset:72
    buffer_load_ushort v33, v2, s[28:31], s55 offen offset:72
    buffer_load_ushort v34, v2, s[28:31], s56 offen offset:72
    buffer_load_ushort v35, v2, s[28:31], s57 offen offset:72
    buffer_load_ushort v36, v2, s[28:31], s58 offen offset:72
    buffer_load_ushort v37, v2, s[28:31], s59 offen offset:72
    buffer_load_ushort v38, v2, s[28:31], s60 offen offset:72
    buffer_load_ushort v39, v2, s[28:31], s61 offen offset:72
    buffer_load_ushort v40, v3, s[28:31], s54 offen offset:128
    buffer_load_ushort v41, v3, s[28:31], s55 offen offset:128
    buffer_load_ushort v42, v3, s[28:31], s56 offen offset:128
    buffer_load_ushort v43, v3, s[28:31], s57 offen offset:128
    buffer_load_ushort v44, v3, s[28:31], s58 offen offset:128
    buffer_load_ushort v45, v3, s[28:31], s59 offen offset:128
    buffer_load_ushort v46, v3, s[28:31], s60 offen offset:128
    buffer_load_ushort v47, v3, s[28:31], s61 offen offset:128
    s_mul_i32 s50, s46, 5120
    s_add_u32 s50, s50, 13107200
    s_add_u32 s51, s50, 4096
    s_waitcnt vmcnt(0)
    v_lshl_or_b32 v48, v9, 16, v8
    v_lshl_or_b32 v49, v11, 16, v10
    v_lshl_or_b32 v50, v13, 16, v12
    v_lshl_or_b32 v51, v15, 16, v14
    buffer_store_dwordx4 v[48:51], v1, s[24:27], s50 offen offset:0 sc1
    v_lshl_or_b32 v52, v17, 16, v16
    v_lshl_or_b32 v53, v19, 16, v18
    v_lshl_or_b32 v54, v21, 16, v20
    v_lshl_or_b32 v55, v23, 16, v22
    buffer_store_dwordx4 v[52:55], v1, s[24:27], s50 offen offset:1024 sc1
    v_lshl_or_b32 v56, v25, 16, v24
    v_lshl_or_b32 v57, v27, 16, v26
    v_lshl_or_b32 v58, v29, 16, v28
    v_lshl_or_b32 v59, v31, 16, v30
    buffer_store_dwordx4 v[56:59], v1, s[24:27], s50 offen offset:2048 sc1
    v_lshl_or_b32 v60, v33, 16, v32
    v_lshl_or_b32 v61, v35, 16, v34
    v_lshl_or_b32 v62, v37, 16, v36
    v_lshl_or_b32 v63, v39, 16, v38
    buffer_store_dwordx4 v[60:63], v1, s[24:27], s50 offen offset:3072 sc1
    v_lshl_or_b32 v64, v41, 16, v40
    v_lshl_or_b32 v65, v43, 16, v42
    v_lshl_or_b32 v66, v45, 16, v44
    v_lshl_or_b32 v67, v47, 16, v46
    buffer_store_dwordx4 v[64:67], v1, s[24:27], s51 offen offset:0 sc1
    s_add_u32 s45, s45, 8
    s_cmp_lt_u32 s45, 10
    s_waitcnt vmcnt(0)
    s_cbranch_scc1 L_wo_loop
    s_branch L_b1
L_b1:
L_pad2:
    s_cbranch_execz L_pad3
    s_waitcnt lgkmcnt(0)
    s_barrier
    s_and_b32 s43, s2, 7
    s_lshl_b32 s43, s43, 2
    s_lshr_b32 s43, 0x73625140, s43
    s_and_b32 s43, s43, 7
    s_bfe_u32 s44, s2, 0x20003
    s_lshl2_add_u32 s43, s43, s44
    s_lshr_b32 s44, s2, 5
    s_mul_i32 s52, s43, 163840
    v_lshlrev_b32 v1, 4, v0
    s_lshr_b32 s45, s40, 2
    s_and_b32 s46, s40, 3
    s_and_b32 s49, s46, 1
    v_and_b32 v2, 31, v0
    v_lshrrev_b32 v3, 5, v0
    v_lshlrev_b32 v36, 3, v2
    s_lshr_b32 s55, s46, 1
    s_mul_i32 s55, s55, 5120
    s_add_u32 s55, s55, 142848
    s_lshl1_add_u32 s50, s49, s45
    s_lshl_b32 s51, s50, 10
    s_add_u32 s57, s51, s55
    v_add_u32 v67, s57, v1
    s_xor_b32 s51, s51, 1024
    s_add_u32 s57, s51, s55
    v_add_u32 v68, s57, v1
    v_xor_b32 v69, s50, v3
    v_lshl_add_u32 v69, v69, 8, v36
    v_add_u32 v69, s55, v69
    s_lshl_b32 s50, s50, 8
    s_add_u32 s57, s50, s55
    v_add_u32 v70, s57, v36
    s_mul_i32 s47, s40, 10496
    s_add_u32 s47, s47, 16640
    v_lshl_add_u32 v65, v0, 2, s47
    s_add_u32 s47, s40, 8
    s_min_u32 s47, s47, 14
    s_mul_i32 s47, s47, 10496
    s_add_u32 s47, s47, 16640
    v_lshl_add_u32 v66, v0, 2, s47
    s_mov_b32 s48, 0x000f000f
    s_mov_b32 s49, s48
    v_mov_b32 v64, 0x3f803f80
    v_cndmask_b32 v64, 0, v64, s[48:49]
    ds_write_b32 v66, v64
    ds_write_b32 v65, v64
    v_and_b32 v32, 3, v2
    v_and_b32 v33, 4, v2
    v_lshl_or_b32 v32, v33, 2, v32
    v_and_b32 v33, 24, v2
    v_lshrrev_b32 v33, 1, v33
    v_or_b32 v32, v32, v33
    v_lshl_add_u32 v32, v3, 5, v32
    s_lshl_b32 s47, s45, 11
    s_add_u32 s47, s47, 6400
    v_lshl_add_u32 v132, v32, 4, s47
    s_lshl_b32 s47, s45, 9
    s_add_u32 s47, s47, 10496
    v_lshl_add_u32 v133, v32, 3, s47
    v_mad_u32_u24 v32, v3, 20, v2
    s_mul_i32 s47, s45, 2560
    s_add_u32 s47, s47, 11520
    v_lshl_add_u32 v32, v32, 4, s47
    s_mov_b32 s48, 0x00100000
    s_mov_b32 s49, s48
    v_cndmask_b32 v33, 5, 4, s[48:49]
    s_mov_b32 s48, 0xf0000000
    s_mov_b32 s49, s48
    v_cndmask_b32 v33, v33, 13, s[48:49]
    v_lshl_add_u32 v33, v3, 2, v33
    v_and_b32 v33, 15, v33
    v_xor_b32 v34, 8, v33
    s_movk_i32 s47, 16640
    v_lshl_add_u32 v33, v33, 4, s47
    v_lshl_add_u32 v34, v34, 4, s47
    s_mov_b32 s48, 0x000fffff
    s_mov_b32 s49, s48
    v_cndmask_b32 v134, v33, v32, s[48:49]
    v_add_u32 v32, 640, v32
    v_cndmask_b32 v135, v34, v32, s[48:49]
    v_add_u32 v32, 640, v32
    v_cndmask_b32 v136, v33, v32, s[48:49]
    v_add_u32 v32, 640, v32
    v_cndmask_b32 v137, v34, v32, s[48:49]
    s_mov_b32 s47, 62976
    v_add_u32 v138, s47, v132
    v_add_u32 v139, s47, v133
    v_add_u32 v140, s47, v134
    v_add_u32 v141, s47, v135
    v_add_u32 v142, s47, v136
    v_add_u32 v143, s47, v137
    s_mov_b32 s47, 125952
    v_add_u32 v144, s47, v132
    v_add_u32 v145, s47, v133
    v_add_u32 v146, s47, v134
    v_add_u32 v147, s47, v135
    v_add_u32 v148, s47, v136
    v_add_u32 v149, s47, v137
    s_cmp_eq_u32 s45, 0
    s_cselect_b32 s47, 1, -1
    s_mul_i32 s50, s47, 2560
    v_mov_b32 v32, s50
    v_cndmask_b32 v32, 0, v32, s[48:49]
    s_lshl_b32 s50, s47, 11
    v_add_u32 v150, s50, v144
    s_lshl_b32 s50, s47, 9
    v_add_u32 v151, s50, v145
    v_add_u32 v152, v32, v146
    v_add_u32 v153, v32, v147
    v_add_u32 v154, v32, v148
    v_add_u32 v155, v32, v149
    s_mul_i32 s47, s40, 3072
    s_xor_b32 s48, s40, 4
    s_mul_i32 s48, s48, 3072
    s_add_u32 s47, s47, 102400
    s_add_u32 s48, s48, 102400
    v_add_u32 v156, s47, v1
    v_add_u32 v157, s48, v1
    s_lshl2_add_u32 s47, s44, s46
    s_lshl1_add_u32 s47, s47, s45
    s_mul_i32 s47, s47, 40960
    s_add_u32 s47, s47, 10485760
    s_lshr_b32 s48, s43, 3
    s_mul_i32 s48, s48, 10240
    s_add_u32 s47, s47, s48
    s_and_b32 s48, s43, 7
    s_lshl_b32 s53, s48, 10
    s_add_u32 s53, s53, s47
    s_lshl_b32 s54, s48, 8
    s_add_u32 s54, s54, s47
    s_add_u32 s54, s54, 8192
    s_mov_b32 s48, 0
    s_mov_b32 s49, -1
    v_cndmask_b32 v158, v36, 2.0, s[48:49]
    v_mov_b32 v14, 0xdddddddd
    s_mov_b32 s60, 0x37800000
    s_mov_b32 s61, 0x5f800000
    v_mov_b64 v[96:97], 0
    v_mov_b64 v[98:99], 0
    v_mov_b64 v[100:101], 0
    v_mov_b64 v[102:103], 0
    v_mov_b64 v[104:105], 0
    v_mov_b64 v[106:107], 0
    v_mov_b64 v[108:109], 0
    v_mov_b64 v[110:111], 0
    v_mov_b64 v[112:113], 0
    v_mov_b64 v[114:115], 0
    v_mov_b64 v[116:117], 0
    v_mov_b64 v[118:119], 0
    v_mov_b64 v[120:121], 0
    v_mov_b64 v[122:123], 0
    v_mov_b64 v[124:125], 0
    v_mov_b64 v[126:127], 0
    s_mov_b32 s56, 0
    s_waitcnt lgkmcnt(0)
    s_barrier
    ds_read_b64 v[12:13], v69 offset:4096
    ds_read_b64 v[20:21], v145 offset:20992
    ds_read_b128 v[4:7], v67
    ds_read_b128 v[16:19], v144 offset:20992
    ds_read_b128 v[8:11], v68
    s_waitcnt lgkmcnt(3)
    v_mfma_f32_32x32x4_2b_bf16 v[32:63], v[20:21], v[12:13], 0 cbsz:1 abid:0
    ds_read_b128 v[160:163], v144 offset:22016
    ds_read_b64 v[2:3], v70 offset:4096
    ds_read_b128 v[24:27], v146 offset:20992
    ds_read_b128 v[28:31], v147 offset:20992
    s_nop 12
    s_waitcnt lgkmcnt(4)
    v_mfma_f32_32x32x16_bf16 v[32:47], v[16:19], v[4:7], v[32:47]
    v_mfma_f32_32x32x16_bf16 v[48:63], v[16:19], v[8:11], v[48:63]
    s_nop 10
    v_exp_f32 v32, v32
    v_exp_f32 v33, v33
    v_exp_f32 v34, v34
    v_exp_f32 v35, v35
    v_exp_f32 v36, v36
    v_exp_f32 v37, v37
    v_exp_f32 v38, v38
    v_mfma_f32_32x32x4_2b_bf16 v[64:95], v[20:21], v[12:13], 0 cbsz:1 abid:1
    v_exp_f32 v39, v39
    v_exp_f32 v40, v40
    v_exp_f32 v41, v41
    v_exp_f32 v42, v42
    v_exp_f32 v43, v43
    v_exp_f32 v44, v44
    v_exp_f32 v45, v45
    v_exp_f32 v46, v46
    s_waitcnt lgkmcnt(0)
    v_smfmac_f32_32x32x32_bf16 v[96:111], v[24:27], v[32:39], v14
    v_exp_f32 v47, v47
    v_exp_f32 v48, v48
    v_exp_f32 v49, v49
    v_exp_f32 v50, v50
    v_smfmac_f32_32x32x32_bf16 v[96:111], v[28:31], v[40:47], v14
    v_exp_f32 v51, v51
    v_exp_f32 v52, v52
    v_exp_f32 v53, v53
    v_exp_f32 v54, v54
    v_mfma_f32_32x32x16_bf16 v[64:79], v[160:163], v[4:7], v[64:79]
    v_exp_f32 v55, v55
    v_exp_f32 v56, v56
    v_exp_f32 v57, v57
    v_exp_f32 v58, v58
    v_smfmac_f32_32x32x32_bf16 v[112:127], v[24:27], v[48:55], v14
    v_exp_f32 v59, v59
    v_exp_f32 v60, v60
    v_exp_f32 v61, v61
    v_exp_f32 v62, v62
    v_mfma_f32_32x32x16_bf16 v[80:95], v[160:163], v[8:11], v[80:95]
    s_barrier
    ds_read_b64 v[22:23], v133 offset:0
    ds_read_b128 v[16:19], v132 offset:0
    ds_read_b128 v[24:27], v148 offset:20992
    ds_read_b128 v[128:131], v149 offset:20992
    v_exp_f32 v63, v63
    v_exp_f32 v64, v64
    v_exp_f32 v65, v65
    v_exp_f32 v66, v66
    v_smfmac_f32_32x32x32_bf16 v[112:127], v[28:31], v[56:63], v14
    v_exp_f32 v67, v67
    v_exp_f32 v68, v68
    v_exp_f32 v69, v69
    v_exp_f32 v70, v70
    s_waitcnt lgkmcnt(3)
    v_mfma_f32_32x32x4_2b_bf16 v[32:63], v[22:23], v[12:13], 0 cbsz:1 abid:0
    v_exp_f32 v71, v71
    v_exp_f32 v72, v72
    v_exp_f32 v73, v73
    v_exp_f32 v74, v74
    v_exp_f32 v75, v75
    v_exp_f32 v76, v76
    v_exp_f32 v77, v77
    v_exp_f32 v78, v78
    s_waitcnt lgkmcnt(0)
    v_smfmac_f32_32x32x32_bf16 v[96:111], v[24:27], v[64:71], v14
    v_exp_f32 v79, v79
    v_exp_f32 v80, v80
    v_exp_f32 v81, v81
    v_exp_f32 v82, v82
    s_barrier
    s_setprio 3
    ds_read_b64 v[20:21], v133 offset:10496
    v_smfmac_f32_32x32x32_bf16 v[96:111], v[128:131], v[72:79], v14
    v_exp_f32 v83, v83
    v_exp_f32 v84, v84
    v_exp_f32 v85, v85
    v_exp_f32 v86, v86
    ds_read_b128 v[28:31], v135 offset:0
    v_mfma_f32_32x32x16_bf16 v[32:47], v[16:19], v[4:7], v[32:47]
    v_exp_f32 v87, v87
    v_exp_f32 v88, v88
    v_exp_f32 v89, v89
    v_exp_f32 v90, v90
    ds_read_b128 v[160:163], v132 offset:1024
    v_smfmac_f32_32x32x32_bf16 v[112:127], v[24:27], v[80:87], v14
    v_exp_f32 v91, v91
    v_exp_f32 v92, v92
    v_exp_f32 v93, v93
    v_exp_f32 v94, v94
    ds_read_b128 v[24:27], v134 offset:0
    v_mfma_f32_32x32x16_bf16 v[48:63], v[16:19], v[8:11], v[48:63]
    v_exp_f32 v95, v95
    v_exp_f32 v32, v32
    v_exp_f32 v33, v33
    v_exp_f32 v34, v34
    v_smfmac_f32_32x32x32_bf16 v[112:127], v[128:131], v[88:95], v14
    v_exp_f32 v35, v35
    v_exp_f32 v36, v36
    v_exp_f32 v37, v37
    v_exp_f32 v38, v38
    v_mfma_f32_32x32x4_2b_bf16 v[64:95], v[22:23], v[12:13], 0 cbsz:1 abid:1
    v_exp_f32 v39, v39
    v_exp_f32 v40, v40
    v_exp_f32 v41, v41
    v_exp_f32 v42, v42
    v_exp_f32 v43, v43
    v_exp_f32 v44, v44
    v_exp_f32 v45, v45
    v_exp_f32 v46, v46
    s_waitcnt lgkmcnt(0)
    v_smfmac_f32_32x32x32_bf16 v[96:111], v[24:27], v[32:39], v14
    v_exp_f32 v47, v47
    v_exp_f32 v48, v48
    v_exp_f32 v49, v49
    v_exp_f32 v50, v50
    v_smfmac_f32_32x32x32_bf16 v[96:111], v[28:31], v[40:47], v14
    v_exp_f32 v51, v51
    v_exp_f32 v52, v52
    v_exp_f32 v53, v53
    v_exp_f32 v54, v54
    ds_read_b128 v[128:131], v137 offset:0
    v_mfma_f32_32x32x16_bf16 v[64:79], v[160:163], v[4:7], v[64:79]
    v_exp_f32 v55, v55
    v_exp_f32 v56, v56
    v_exp_f32 v57, v57
    v_exp_f32 v58, v58
    ds_read_b128 v[16:19], v132 offset:10496
    v_smfmac_f32_32x32x32_bf16 v[112:127], v[24:27], v[48:55], v14
    v_exp_f32 v59, v59
    v_exp_f32 v60, v60
    v_exp_f32 v61, v61
    v_exp_f32 v62, v62
    ds_read_b128 v[24:27], v136 offset:0
    v_mfma_f32_32x32x16_bf16 v[80:95], v[160:163], v[8:11], v[80:95]
    v_exp_f32 v63, v63
    v_exp_f32 v64, v64
    v_exp_f32 v65, v65
    v_exp_f32 v66, v66
    v_smfmac_f32_32x32x32_bf16 v[112:127], v[28:31], v[56:63], v14
    v_exp_f32 v67, v67
    v_exp_f32 v68, v68
    v_exp_f32 v69, v69
    v_exp_f32 v70, v70
    v_mfma_f32_32x32x4_2b_bf16 v[32:63], v[20:21], v[12:13], 0 cbsz:1 abid:0
    v_exp_f32 v71, v71
    v_exp_f32 v72, v72
    v_exp_f32 v73, v73
    v_exp_f32 v74, v74
    v_exp_f32 v75, v75
    v_exp_f32 v76, v76
    v_exp_f32 v77, v77
    v_exp_f32 v78, v78
    s_waitcnt lgkmcnt(0)
    v_smfmac_f32_32x32x32_bf16 v[96:111], v[24:27], v[64:71], v14
    v_exp_f32 v79, v79
    v_exp_f32 v80, v80
    v_exp_f32 v81, v81
    v_exp_f32 v82, v82
    ds_read_b64 v[22:23], v133 offset:20992
    v_smfmac_f32_32x32x32_bf16 v[96:111], v[128:131], v[72:79], v14
    v_exp_f32 v83, v83
    v_exp_f32 v84, v84
    v_exp_f32 v85, v85
    v_exp_f32 v86, v86
    ds_read_b128 v[28:31], v135 offset:10496
    v_mfma_f32_32x32x16_bf16 v[32:47], v[16:19], v[4:7], v[32:47]
    v_exp_f32 v87, v87
    v_exp_f32 v88, v88
    v_exp_f32 v89, v89
    v_exp_f32 v90, v90
    ds_read_b128 v[160:163], v132 offset:11520
    v_smfmac_f32_32x32x32_bf16 v[112:127], v[24:27], v[80:87], v14
    v_exp_f32 v91, v91
    v_exp_f32 v92, v92
    v_exp_f32 v93, v93
    v_exp_f32 v94, v94
    s_setprio 2
    ds_read_b128 v[24:27], v134 offset:10496
    v_mfma_f32_32x32x16_bf16 v[48:63], v[16:19], v[8:11], v[48:63]
    v_exp_f32 v95, v95
    v_exp_f32 v32, v32
    v_exp_f32 v33, v33
    v_exp_f32 v34, v34
    v_smfmac_f32_32x32x32_bf16 v[112:127], v[128:131], v[88:95], v14
    v_exp_f32 v35, v35
    v_exp_f32 v36, v36
    v_exp_f32 v37, v37
    v_exp_f32 v38, v38
    v_mfma_f32_32x32x4_2b_bf16 v[64:95], v[20:21], v[12:13], 0 cbsz:1 abid:1
    v_exp_f32 v39, v39
    v_exp_f32 v40, v40
    v_exp_f32 v41, v41
    v_exp_f32 v42, v42
    v_exp_f32 v43, v43
    v_exp_f32 v44, v44
    v_exp_f32 v45, v45
    v_exp_f32 v46, v46
    s_waitcnt lgkmcnt(0)
    v_smfmac_f32_32x32x32_bf16 v[96:111], v[24:27], v[32:39], v14
    v_exp_f32 v47, v47
    v_exp_f32 v48, v48
    v_exp_f32 v49, v49
    v_exp_f32 v50, v50
    v_smfmac_f32_32x32x32_bf16 v[96:111], v[28:31], v[40:47], v14
    v_exp_f32 v51, v51
    v_exp_f32 v52, v52
    v_exp_f32 v53, v53
    v_exp_f32 v54, v54
    ds_read_b128 v[128:131], v137 offset:10496
    v_mfma_f32_32x32x16_bf16 v[64:79], v[160:163], v[4:7], v[64:79]
    v_exp_f32 v55, v55
    v_exp_f32 v56, v56
    v_exp_f32 v57, v57
    v_exp_f32 v58, v58
    ds_read_b128 v[16:19], v132 offset:20992
    v_smfmac_f32_32x32x32_bf16 v[112:127], v[24:27], v[48:55], v14
    v_exp_f32 v59, v59
    v_exp_f32 v60, v60
    v_exp_f32 v61, v61
    v_exp_f32 v62, v62
    s_setprio 1
    ds_read_b128 v[24:27], v136 offset:10496
    v_mfma_f32_32x32x16_bf16 v[80:95], v[160:163], v[8:11], v[80:95]
    v_exp_f32 v63, v63
    v_exp_f32 v64, v64
    v_exp_f32 v65, v65
    v_exp_f32 v66, v66
    v_smfmac_f32_32x32x32_bf16 v[112:127], v[28:31], v[56:63], v14
    v_exp_f32 v67, v67
    v_exp_f32 v68, v68
    v_exp_f32 v69, v69
    v_exp_f32 v70, v70
    v_mfma_f32_32x32x4_2b_bf16 v[32:63], v[22:23], v[12:13], 0 cbsz:1 abid:0
    v_exp_f32 v71, v71
    v_exp_f32 v72, v72
    v_exp_f32 v73, v73
    v_exp_f32 v74, v74
    v_exp_f32 v75, v75
    s_setprio 0
    v_exp_f32 v76, v76
    v_exp_f32 v77, v77
    v_exp_f32 v78, v78
    s_waitcnt lgkmcnt(0)
    v_smfmac_f32_32x32x32_bf16 v[96:111], v[24:27], v[64:71], v14
    v_exp_f32 v79, v79
    v_exp_f32 v80, v80
    v_exp_f32 v81, v81
    v_exp_f32 v82, v82
    s_barrier
    s_setprio 3
    ds_read_b64 v[20:21], v133 offset:31488
    v_smfmac_f32_32x32x32_bf16 v[96:111], v[128:131], v[72:79], v14
    v_exp_f32 v83, v83
    v_exp_f32 v84, v84
    v_exp_f32 v85, v85
    v_exp_f32 v86, v86
    ds_read_b128 v[28:31], v135 offset:20992
    v_mfma_f32_32x32x16_bf16 v[32:47], v[16:19], v[4:7], v[32:47]
    v_exp_f32 v87, v87
    v_exp_f32 v88, v88
    v_exp_f32 v89, v89
    v_exp_f32 v90, v90
    ds_read_b128 v[160:163], v132 offset:22016
    v_smfmac_f32_32x32x32_bf16 v[112:127], v[24:27], v[80:87], v14
    v_exp_f32 v91, v91
    v_exp_f32 v92, v92
    v_exp_f32 v93, v93
    v_exp_f32 v94, v94
    ds_read_b128 v[24:27], v134 offset:20992
    v_mfma_f32_32x32x16_bf16 v[48:63], v[16:19], v[8:11], v[48:63]
    v_exp_f32 v95, v95
    v_exp_f32 v32, v32
    v_exp_f32 v33, v33
    v_exp_f32 v34, v34
    v_smfmac_f32_32x32x32_bf16 v[112:127], v[128:131], v[88:95], v14
    v_exp_f32 v35, v35
    v_exp_f32 v36, v36
    v_exp_f32 v37, v37
    v_exp_f32 v38, v38
    v_mfma_f32_32x32x4_2b_bf16 v[64:95], v[22:23], v[12:13], 0 cbsz:1 abid:1
    v_exp_f32 v39, v39
    v_exp_f32 v40, v40
    v_exp_f32 v41, v41
    v_exp_f32 v42, v42
    v_exp_f32 v43, v43
    v_exp_f32 v44, v44
    v_exp_f32 v45, v45
    v_exp_f32 v46, v46
    s_waitcnt lgkmcnt(0)
    v_smfmac_f32_32x32x32_bf16 v[96:111], v[24:27], v[32:39], v14
    v_exp_f32 v47, v47
    v_exp_f32 v48, v48
    v_exp_f32 v49, v49
    v_exp_f32 v50, v50
    v_smfmac_f32_32x32x32_bf16 v[96:111], v[28:31], v[40:47], v14
    v_exp_f32 v51, v51
    v_exp_f32 v52, v52
    v_exp_f32 v53, v53
    v_exp_f32 v54, v54
    ds_read_b128 v[128:131], v137 offset:20992
    v_mfma_f32_32x32x16_bf16 v[64:79], v[160:163], v[4:7], v[64:79]
    v_exp_f32 v55, v55
    v_exp_f32 v56, v56
    v_exp_f32 v57, v57
    v_exp_f32 v58, v58
    ds_read_b128 v[16:19], v132 offset:31488
    v_smfmac_f32_32x32x32_bf16 v[112:127], v[24:27], v[48:55], v14
    v_exp_f32 v59, v59
    v_exp_f32 v60, v60
    v_exp_f32 v61, v61
    v_exp_f32 v62, v62
    ds_read_b128 v[24:27], v136 offset:20992
    v_mfma_f32_32x32x16_bf16 v[80:95], v[160:163], v[8:11], v[80:95]
    v_exp_f32 v63, v63
    v_exp_f32 v64, v64
    v_exp_f32 v65, v65
    v_exp_f32 v66, v66
    v_smfmac_f32_32x32x32_bf16 v[112:127], v[28:31], v[56:63], v14
    v_exp_f32 v67, v67
    v_exp_f32 v68, v68
    v_exp_f32 v69, v69
    v_exp_f32 v70, v70
    v_mfma_f32_32x32x4_2b_bf16 v[32:63], v[20:21], v[12:13], 0 cbsz:1 abid:0
    v_exp_f32 v71, v71
    v_exp_f32 v72, v72
    v_exp_f32 v73, v73
    v_exp_f32 v74, v74
    v_exp_f32 v75, v75
    v_exp_f32 v76, v76
    v_exp_f32 v77, v77
    v_exp_f32 v78, v78
    s_waitcnt lgkmcnt(0)
    v_smfmac_f32_32x32x32_bf16 v[96:111], v[24:27], v[64:71], v14
    v_exp_f32 v79, v79
    v_exp_f32 v80, v80
    v_exp_f32 v81, v81
    v_exp_f32 v82, v82
    ds_read_b64 v[22:23], v133 offset:41984
    v_smfmac_f32_32x32x32_bf16 v[96:111], v[128:131], v[72:79], v14
    v_exp_f32 v83, v83
    v_exp_f32 v84, v84
    v_exp_f32 v85, v85
    v_exp_f32 v86, v86
    ds_read_b128 v[28:31], v135 offset:31488
    v_mfma_f32_32x32x16_bf16 v[32:47], v[16:19], v[4:7], v[32:47]
    v_exp_f32 v87, v87
    v_exp_f32 v88, v88
    v_exp_f32 v89, v89
    v_exp_f32 v90, v90
    ds_read_b128 v[160:163], v132 offset:32512
    v_smfmac_f32_32x32x32_bf16 v[112:127], v[24:27], v[80:87], v14
    v_exp_f32 v91, v91
    v_exp_f32 v92, v92
    v_exp_f32 v93, v93
    v_exp_f32 v94, v94
    ds_read_b128 v[24:27], v134 offset:31488
    v_mfma_f32_32x32x16_bf16 v[48:63], v[16:19], v[8:11], v[48:63]
    v_exp_f32 v95, v95
    v_exp_f32 v32, v32
    v_exp_f32 v33, v33
    v_exp_f32 v34, v34
    v_smfmac_f32_32x32x32_bf16 v[112:127], v[128:131], v[88:95], v14
    v_exp_f32 v35, v35
    v_exp_f32 v36, v36
    v_exp_f32 v37, v37
    v_exp_f32 v38, v38
    v_mfma_f32_32x32x4_2b_bf16 v[64:95], v[20:21], v[12:13], 0 cbsz:1 abid:1
    v_exp_f32 v39, v39
    v_exp_f32 v40, v40
    v_exp_f32 v41, v41
    v_exp_f32 v42, v42
    v_exp_f32 v43, v43
    v_exp_f32 v44, v44
    v_exp_f32 v45, v45
    v_exp_f32 v46, v46
    s_waitcnt lgkmcnt(0)
    v_smfmac_f32_32x32x32_bf16 v[96:111], v[24:27], v[32:39], v14
    v_exp_f32 v47, v47
    v_exp_f32 v48, v48
    v_exp_f32 v49, v49
    v_exp_f32 v50, v50
    v_smfmac_f32_32x32x32_bf16 v[96:111], v[28:31], v[40:47], v14
    v_exp_f32 v51, v51
    v_exp_f32 v52, v52
    v_exp_f32 v53, v53
    v_exp_f32 v54, v54
    ds_read_b128 v[128:131], v137 offset:31488
    v_mfma_f32_32x32x16_bf16 v[64:79], v[160:163], v[4:7], v[64:79]
    v_exp_f32 v55, v55
    v_exp_f32 v56, v56
    v_exp_f32 v57, v57
    v_exp_f32 v58, v58
    ds_read_b128 v[16:19], v132 offset:41984
    v_smfmac_f32_32x32x32_bf16 v[112:127], v[24:27], v[48:55], v14
    v_exp_f32 v59, v59
    v_exp_f32 v60, v60
    v_exp_f32 v61, v61
    v_exp_f32 v62, v62
    ds_read_b128 v[24:27], v136 offset:31488
    v_mfma_f32_32x32x16_bf16 v[80:95], v[160:163], v[8:11], v[80:95]
    v_exp_f32 v63, v63
    v_exp_f32 v64, v64
    v_exp_f32 v65, v65
    v_exp_f32 v66, v66
    v_smfmac_f32_32x32x32_bf16 v[112:127], v[28:31], v[56:63], v14
    v_exp_f32 v67, v67
    v_exp_f32 v68, v68
    v_exp_f32 v69, v69
    v_exp_f32 v70, v70
    v_mfma_f32_32x32x4_2b_bf16 v[32:63], v[22:23], v[12:13], 0 cbsz:1 abid:0
    v_exp_f32 v71, v71
    v_exp_f32 v72, v72
    v_exp_f32 v73, v73
    v_exp_f32 v74, v74
    v_exp_f32 v75, v75
    v_exp_f32 v76, v76
    v_exp_f32 v77, v77
    v_exp_f32 v78, v78
    s_waitcnt lgkmcnt(0)
    v_smfmac_f32_32x32x32_bf16 v[96:111], v[24:27], v[64:71], v14
    v_exp_f32 v79, v79
    v_exp_f32 v80, v80
    v_exp_f32 v81, v81
    v_exp_f32 v82, v82
    ds_read_b64 v[20:21], v133 offset:52480
    v_smfmac_f32_32x32x32_bf16 v[96:111], v[128:131], v[72:79], v14
    v_exp_f32 v83, v83
    v_exp_f32 v84, v84
    v_exp_f32 v85, v85
    v_exp_f32 v86, v86
    ds_read_b128 v[28:31], v135 offset:41984
    v_mfma_f32_32x32x16_bf16 v[32:47], v[16:19], v[4:7], v[32:47]
    v_exp_f32 v87, v87
    v_exp_f32 v88, v88
    v_exp_f32 v89, v89
    v_exp_f32 v90, v90
    ds_read_b128 v[160:163], v132 offset:43008
    v_smfmac_f32_32x32x32_bf16 v[112:127], v[24:27], v[80:87], v14
    v_exp_f32 v91, v91
    v_exp_f32 v92, v92
    v_exp_f32 v93, v93
    v_exp_f32 v94, v94
    ds_read_b128 v[24:27], v134 offset:41984
    v_mfma_f32_32x32x16_bf16 v[48:63], v[16:19], v[8:11], v[48:63]
    v_exp_f32 v95, v95
    v_exp_f32 v32, v32
    v_exp_f32 v33, v33
    v_exp_f32 v34, v34
    v_smfmac_f32_32x32x32_bf16 v[112:127], v[128:131], v[88:95], v14
L_pad3:
    s_cbranch_execz L_padret
    v_exp_f32 v35, v35
    v_exp_f32 v36, v36
    v_exp_f32 v37, v37
    v_exp_f32 v38, v38
    v_mfma_f32_32x32x4_2b_bf16 v[64:95], v[22:23], v[12:13], 0 cbsz:1 abid:1
    v_exp_f32 v39, v39
    v_exp_f32 v40, v40
    v_exp_f32 v41, v41
    v_exp_f32 v42, v42
    v_exp_f32 v43, v43
    s_setprio 2
    v_exp_f32 v44, v44
    v_exp_f32 v45, v45
    v_exp_f32 v46, v46
    s_waitcnt lgkmcnt(0)
    v_smfmac_f32_32x32x32_bf16 v[96:111], v[24:27], v[32:39], v14
    v_exp_f32 v47, v47
    v_exp_f32 v48, v48
    v_exp_f32 v49, v49
    v_exp_f32 v50, v50
    v_smfmac_f32_32x32x32_bf16 v[96:111], v[28:31], v[40:47], v14
    v_exp_f32 v51, v51
    v_exp_f32 v52, v52
    v_exp_f32 v53, v53
    v_exp_f32 v54, v54
    ds_read_b128 v[128:131], v137 offset:41984
    v_mfma_f32_32x32x16_bf16 v[64:79], v[160:163], v[4:7], v[64:79]
    v_exp_f32 v55, v55
    v_exp_f32 v56, v56
    v_exp_f32 v57, v57
    v_exp_f32 v58, v58
    ds_read_b128 v[16:19], v132 offset:52480
    v_smfmac_f32_32x32x32_bf16 v[112:127], v[24:27], v[48:55], v14
    v_exp_f32 v59, v59
    v_exp_f32 v60, v60
    v_exp_f32 v61, v61
    v_exp_f32 v62, v62
    ds_read_b128 v[24:27], v136 offset:41984
    v_mfma_f32_32x32x16_bf16 v[80:95], v[160:163], v[8:11], v[80:95]
    v_exp_f32 v63, v63
    v_exp_f32 v64, v64
    v_exp_f32 v65, v65
    v_exp_f32 v66, v66
    v_smfmac_f32_32x32x32_bf16 v[112:127], v[28:31], v[56:63], v14
    v_exp_f32 v67, v67
    v_exp_f32 v68, v68
    v_exp_f32 v69, v69
    v_exp_f32 v70, v70
    v_mfma_f32_32x32x4_2b_bf16 v[32:63], v[20:21], v[12:13], 0 cbsz:1 abid:0
    v_exp_f32 v71, v71
    v_exp_f32 v72, v72
    v_exp_f32 v73, v73
    v_exp_f32 v74, v74
    v_exp_f32 v75, v75
    v_exp_f32 v76, v76
    v_exp_f32 v77, v77
    v_exp_f32 v78, v78
    s_waitcnt lgkmcnt(0)
    v_smfmac_f32_32x32x32_bf16 v[96:111], v[24:27], v[64:71], v14
    v_exp_f32 v79, v79
    v_exp_f32 v80, v80
    v_exp_f32 v81, v81
    v_exp_f32 v82, v82
    ds_read_b64 v[22:23], v139 offset:0
    v_smfmac_f32_32x32x32_bf16 v[96:111], v[128:131], v[72:79], v14
    v_exp_f32 v83, v83
    v_exp_f32 v84, v84
    v_exp_f32 v85, v85
    v_exp_f32 v86, v86
    ds_read_b128 v[28:31], v135 offset:52480
    v_mfma_f32_32x32x16_bf16 v[32:47], v[16:19], v[4:7], v[32:47]
    v_exp_f32 v87, v87
    v_exp_f32 v88, v88
    v_exp_f32 v89, v89
    v_exp_f32 v90, v90
    ds_read_b128 v[160:163], v132 offset:53504
    v_smfmac_f32_32x32x32_bf16 v[112:127], v[24:27], v[80:87], v14
    v_exp_f32 v91, v91
    v_exp_f32 v92, v92
    v_exp_f32 v93, v93
    v_exp_f32 v94, v94
    ds_read_b128 v[24:27], v134 offset:52480
    v_mfma_f32_32x32x16_bf16 v[48:63], v[16:19], v[8:11], v[48:63]
    v_exp_f32 v95, v95
    v_exp_f32 v32, v32
    v_exp_f32 v33, v33
    v_exp_f32 v34, v34
    v_smfmac_f32_32x32x32_bf16 v[112:127], v[128:131], v[88:95], v14
    v_exp_f32 v35, v35
    v_exp_f32 v36, v36
    v_exp_f32 v37, v37
    v_exp_f32 v38, v38
    v_mfma_f32_32x32x4_2b_bf16 v[64:95], v[20:21], v[12:13], 0 cbsz:1 abid:1
    v_exp_f32 v39, v39
    v_exp_f32 v40, v40
    v_exp_f32 v41, v41
    v_exp_f32 v42, v42
    v_exp_f32 v43, v43
    s_setprio 1
    v_exp_f32 v44, v44
    v_exp_f32 v45, v45
    v_exp_f32 v46, v46
    s_waitcnt lgkmcnt(0)
    v_smfmac_f32_32x32x32_bf16 v[96:111], v[24:27], v[32:39], v14
    v_exp_f32 v47, v47
    v_exp_f32 v48, v48
    v_exp_f32 v49, v49
    v_exp_f32 v50, v50
    v_smfmac_f32_32x32x32_bf16 v[96:111], v[28:31], v[40:47], v14
    v_exp_f32 v51, v51
    v_exp_f32 v52, v52
    v_exp_f32 v53, v53
    v_exp_f32 v54, v54
    ds_read_b128 v[128:131], v137 offset:52480
    v_mfma_f32_32x32x16_bf16 v[64:79], v[160:163], v[4:7], v[64:79]
    v_exp_f32 v55, v55
    v_exp_f32 v56, v56
    v_exp_f32 v57, v57
    v_exp_f32 v58, v58
    ds_read_b128 v[16:19], v138 offset:0
    v_smfmac_f32_32x32x32_bf16 v[112:127], v[24:27], v[48:55], v14
    v_exp_f32 v59, v59
    v_exp_f32 v60, v60
    v_exp_f32 v61, v61
    v_exp_f32 v62, v62
    ds_read_b128 v[24:27], v136 offset:52480
    v_mfma_f32_32x32x16_bf16 v[80:95], v[160:163], v[8:11], v[80:95]
    v_exp_f32 v63, v63
    v_exp_f32 v64, v64
    v_exp_f32 v65, v65
    v_exp_f32 v66, v66
    v_smfmac_f32_32x32x32_bf16 v[112:127], v[28:31], v[56:63], v14
    v_exp_f32 v67, v67
    s_setprio 0
    v_exp_f32 v68, v68
    v_exp_f32 v69, v69
    v_exp_f32 v70, v70
    v_mfma_f32_32x32x4_2b_bf16 v[32:63], v[22:23], v[12:13], 0 cbsz:1 abid:0
    v_exp_f32 v71, v71
    v_exp_f32 v72, v72
    v_exp_f32 v73, v73
    v_exp_f32 v74, v74
    v_exp_f32 v75, v75
    v_exp_f32 v76, v76
    v_exp_f32 v77, v77
    v_exp_f32 v78, v78
    s_waitcnt lgkmcnt(0)
    v_smfmac_f32_32x32x32_bf16 v[96:111], v[24:27], v[64:71], v14
    v_exp_f32 v79, v79
    v_exp_f32 v80, v80
    v_exp_f32 v81, v81
    v_exp_f32 v82, v82
    s_barrier
    s_setprio 3
    ds_read_b64 v[20:21], v139 offset:10496
    v_smfmac_f32_32x32x32_bf16 v[96:111], v[128:131], v[72:79], v14
    v_exp_f32 v83, v83
    v_exp_f32 v84, v84
    v_exp_f32 v85, v85
    v_exp_f32 v86, v86
    ds_read_b128 v[28:31], v141 offset:0
    v_mfma_f32_32x32x16_bf16 v[32:47], v[16:19], v[4:7], v[32:47]
    v_exp_f32 v87, v87
    v_exp_f32 v88, v88
    v_exp_f32 v89, v89
    v_exp_f32 v90, v90
    ds_read_b128 v[160:163], v138 offset:1024
    v_smfmac_f32_32x32x32_bf16 v[112:127], v[24:27], v[80:87], v14
    v_exp_f32 v91, v91
    v_exp_f32 v92, v92
    v_exp_f32 v93, v93
    v_exp_f32 v94, v94
    ds_read_b128 v[24:27], v140 offset:0
    v_mfma_f32_32x32x16_bf16 v[48:63], v[16:19], v[8:11], v[48:63]
    v_exp_f32 v95, v95
    v_exp_f32 v32, v32
    v_exp_f32 v33, v33
    v_exp_f32 v34, v34
    v_smfmac_f32_32x32x32_bf16 v[112:127], v[128:131], v[88:95], v14
    v_exp_f32 v35, v35
    v_exp_f32 v36, v36
    v_exp_f32 v37, v37
    v_exp_f32 v38, v38
    v_mfma_f32_32x32x4_2b_bf16 v[64:95], v[22:23], v[12:13], 0 cbsz:1 abid:1
    v_exp_f32 v39, v39
    v_exp_f32 v40, v40
    v_exp_f32 v41, v41
    v_exp_f32 v42, v42
    v_exp_f32 v43, v43
    v_exp_f32 v44, v44
    v_exp_f32 v45, v45
    v_exp_f32 v46, v46
    s_waitcnt lgkmcnt(0)
    v_smfmac_f32_32x32x32_bf16 v[96:111], v[24:27], v[32:39], v14
    v_exp_f32 v47, v47
    v_exp_f32 v48, v48
    v_exp_f32 v49, v49
    v_exp_f32 v50, v50
    v_smfmac_f32_32x32x32_bf16 v[96:111], v[28:31], v[40:47], v14
    v_exp_f32 v51, v51
    v_exp_f32 v52, v52
    v_exp_f32 v53, v53
    v_exp_f32 v54, v54
    ds_read_b128 v[128:131], v143 offset:0
    v_mfma_f32_32x32x16_bf16 v[64:79], v[160:163], v[4:7], v[64:79]
    v_exp_f32 v55, v55
    v_exp_f32 v56, v56
    v_exp_f32 v57, v57
    v_exp_f32 v58, v58
    ds_read_b128 v[16:19], v138 offset:10496
    v_smfmac_f32_32x32x32_bf16 v[112:127], v[24:27], v[48:55], v14
    v_exp_f32 v59, v59
    v_exp_f32 v60, v60
    v_exp_f32 v61, v61
    v_exp_f32 v62, v62
    ds_read_b128 v[24:27], v142 offset:0
    v_mfma_f32_32x32x16_bf16 v[80:95], v[160:163], v[8:11], v[80:95]
    v_exp_f32 v63, v63
    v_exp_f32 v64, v64
    v_exp_f32 v65, v65
    v_exp_f32 v66, v66
    v_smfmac_f32_32x32x32_bf16 v[112:127], v[28:31], v[56:63], v14
    v_exp_f32 v67, v67
    v_exp_f32 v68, v68
    v_exp_f32 v69, v69
    v_exp_f32 v70, v70
    v_mfma_f32_32x32x4_2b_bf16 v[32:63], v[20:21], v[12:13], 0 cbsz:1 abid:0
    v_exp_f32 v71, v71
    v_exp_f32 v72, v72
    v_exp_f32 v73, v73
    v_exp_f32 v74, v74
    v_exp_f32 v75, v75
    v_exp_f32 v76, v76
    v_exp_f32 v77, v77
    v_exp_f32 v78, v78
    s_waitcnt lgkmcnt(0)
    v_smfmac_f32_32x32x32_bf16 v[96:111], v[24:27], v[64:71], v14
    v_exp_f32 v79, v79
    v_exp_f32 v80, v80
    v_exp_f32 v81, v81
    v_exp_f32 v82, v82
    ds_read_b64 v[22:23], v139 offset:20992
    v_smfmac_f32_32x32x32_bf16 v[96:111], v[128:131], v[72:79], v14
    v_exp_f32 v83, v83
    v_exp_f32 v84, v84
    v_exp_f32 v85, v85
    v_exp_f32 v86, v86
    ds_read_b128 v[28:31], v141 offset:10496
    v_mfma_f32_32x32x16_bf16 v[32:47], v[16:19], v[4:7], v[32:47]
    v_exp_f32 v87, v87
    v_exp_f32 v88, v88
    v_exp_f32 v89, v89
    v_exp_f32 v90, v90
    ds_read_b128 v[160:163], v138 offset:11520
    v_smfmac_f32_32x32x32_bf16 v[112:127], v[24:27], v[80:87], v14
    v_exp_f32 v91, v91
    v_exp_f32 v92, v92
    v_exp_f32 v93, v93
    v_exp_f32 v94, v94
    ds_read_b128 v[24:27], v140 offset:10496
    v_mfma_f32_32x32x16_bf16 v[48:63], v[16:19], v[8:11], v[48:63]
    v_exp_f32 v95, v95
    v_exp_f32 v32, v32
    v_exp_f32 v33, v33
    v_exp_f32 v34, v34
    v_smfmac_f32_32x32x32_bf16 v[112:127], v[128:131], v[88:95], v14
    v_exp_f32 v35, v35
    v_exp_f32 v36, v36
    v_exp_f32 v37, v37
    v_exp_f32 v38, v38
    v_mfma_f32_32x32x4_2b_bf16 v[64:95], v[20:21], v[12:13], 0 cbsz:1 abid:1
    v_exp_f32 v39, v39
    v_exp_f32 v40, v40
    v_exp_f32 v41, v41
    v_exp_f32 v42, v42
    v_exp_f32 v43, v43
    v_exp_f32 v44, v44
    v_exp_f32 v45, v45
    v_exp_f32 v46, v46
    s_waitcnt lgkmcnt(0)
    v_smfmac_f32_32x32x32_bf16 v[96:111], v[24:27], v[32:39], v14
    v_exp_f32 v47, v47
    v_exp_f32 v48, v48
    v_exp_f32 v49, v49
    v_exp_f32 v50, v50
    v_smfmac_f32_32x32x32_bf16 v[96:111], v[28:31], v[40:47], v14
    v_exp_f32 v51, v51
    v_exp_f32 v52, v52
    v_exp_f32 v53, v53
    v_exp_f32 v54, v54
    ds_read_b128 v[128:131], v143 offset:10496
    v_mfma_f32_32x32x16_bf16 v[64:79], v[160:163], v[4:7], v[64:79]
    v_exp_f32 v55, v55
    v_exp_f32 v56, v56
    v_exp_f32 v57, v57
    v_exp_f32 v58, v58
    ds_read_b128 v[16:19], v138 offset:20992
    v_smfmac_f32_32x32x32_bf16 v[112:127], v[24:27], v[48:55], v14
    v_exp_f32 v59, v59
    v_exp_f32 v60, v60
    v_exp_f32 v61, v61
    v_exp_f32 v62, v62
    ds_read_b128 v[24:27], v142 offset:10496
    v_mfma_f32_32x32x16_bf16 v[80:95], v[160:163], v[8:11], v[80:95]
    v_exp_f32 v63, v63
    v_exp_f32 v64, v64
    v_exp_f32 v65, v65
    v_exp_f32 v66, v66
    v_smfmac_f32_32x32x32_bf16 v[112:127], v[28:31], v[56:63], v14
    v_exp_f32 v67, v67
    v_exp_f32 v68, v68
    v_exp_f32 v69, v69
    v_exp_f32 v70, v70
    v_mfma_f32_32x32x4_2b_bf16 v[32:63], v[22:23], v[12:13], 0 cbsz:1 abid:0
    v_exp_f32 v71, v71
    v_exp_f32 v72, v72
    v_exp_f32 v73, v73
    v_exp_f32 v74, v74
    v_exp_f32 v75, v75
    v_exp_f32 v76, v76
    v_exp_f32 v77, v77
    v_exp_f32 v78, v78
    s_waitcnt lgkmcnt(0)
    v_smfmac_f32_32x32x32_bf16 v[96:111], v[24:27], v[64:71], v14
    v_exp_f32 v79, v79
    v_exp_f32 v80, v80
    v_exp_f32 v81, v81
    v_exp_f32 v82, v82
    ds_read_b64 v[20:21], v139 offset:31488
    v_smfmac_f32_32x32x32_bf16 v[96:111], v[128:131], v[72:79], v14
    v_exp_f32 v83, v83
    v_exp_f32 v84, v84
    v_exp_f32 v85, v85
    v_exp_f32 v86, v86
    ds_read_b128 v[28:31], v141 offset:20992
    v_mfma_f32_32x32x16_bf16 v[32:47], v[16:19], v[4:7], v[32:47]
    v_exp_f32 v87, v87
    v_exp_f32 v88, v88
    v_exp_f32 v89, v89
    v_exp_f32 v90, v90
    ds_read_b128 v[160:163], v138 offset:22016
    v_smfmac_f32_32x32x32_bf16 v[112:127], v[24:27], v[80:87], v14
    v_exp_f32 v91, v91
    v_exp_f32 v92, v92
    v_exp_f32 v93, v93
    v_exp_f32 v94, v94
    ds_read_b128 v[24:27], v140 offset:20992
    v_mfma_f32_32x32x16_bf16 v[48:63], v[16:19], v[8:11], v[48:63]
    v_exp_f32 v95, v95
    v_exp_f32 v32, v32
    v_exp_f32 v33, v33
    v_exp_f32 v34, v34
    v_smfmac_f32_32x32x32_bf16 v[112:127], v[128:131], v[88:95], v14
    v_exp_f32 v35, v35
    v_exp_f32 v36, v36
    v_exp_f32 v37, v37
    v_exp_f32 v38, v38
    v_mfma_f32_32x32x4_2b_bf16 v[64:95], v[22:23], v[12:13], 0 cbsz:1 abid:1
    v_exp_f32 v39, v39
    v_exp_f32 v40, v40
    v_exp_f32 v41, v41
    v_exp_f32 v42, v42
    v_exp_f32 v43, v43
    v_exp_f32 v44, v44
    v_exp_f32 v45, v45
    v_exp_f32 v46, v46
    s_waitcnt lgkmcnt(0)
    v_smfmac_f32_32x32x32_bf16 v[96:111], v[24:27], v[32:39], v14
    v_exp_f32 v47, v47
    v_exp_f32 v48, v48
    v_exp_f32 v49, v49
    v_exp_f32 v50, v50
    v_smfmac_f32_32x32x32_bf16 v[96:111], v[28:31], v[40:47], v14
    v_exp_f32 v51, v51
    v_exp_f32 v52, v52
    v_exp_f32 v53, v53
    v_exp_f32 v54, v54
    ds_read_b128 v[128:131], v143 offset:20992
    v_mfma_f32_32x32x16_bf16 v[64:79], v[160:163], v[4:7], v[64:79]
    v_exp_f32 v55, v55
    v_exp_f32 v56, v56
    v_exp_f32 v57, v57
    v_exp_f32 v58, v58
    ds_read_b128 v[16:19], v138 offset:31488
    v_smfmac_f32_32x32x32_bf16 v[112:127], v[24:27], v[48:55], v14
    v_exp_f32 v59, v59
    v_exp_f32 v60, v60
    v_exp_f32 v61, v61
    v_exp_f32 v62, v62
    ds_read_b128 v[24:27], v142 offset:20992
    v_mfma_f32_32x32x16_bf16 v[80:95], v[160:163], v[8:11], v[80:95]
    v_exp_f32 v63, v63
    v_exp_f32 v64, v64
    v_exp_f32 v65, v65
    v_exp_f32 v66, v66
    v_smfmac_f32_32x32x32_bf16 v[112:127], v[28:31], v[56:63], v14
    v_exp_f32 v67, v67
    v_exp_f32 v68, v68
    v_exp_f32 v69, v69
    v_exp_f32 v70, v70
    v_mfma_f32_32x32x4_2b_bf16 v[32:63], v[20:21], v[12:13], 0 cbsz:1 abid:0
    v_exp_f32 v71, v71
    v_exp_f32 v72, v72
    v_exp_f32 v73, v73
    v_exp_f32 v74, v74
    v_exp_f32 v75, v75
    v_exp_f32 v76, v76
    v_exp_f32 v77, v77
    v_exp_f32 v78, v78
    s_waitcnt lgkmcnt(0)
    v_smfmac_f32_32x32x32_bf16 v[96:111], v[24:27], v[64:71], v14
    v_exp_f32 v79, v79
    v_exp_f32 v80, v80
    v_exp_f32 v81, v81
    v_exp_f32 v82, v82
    ds_read_b64 v[22:23], v139 offset:41984
    v_smfmac_f32_32x32x32_bf16 v[96:111], v[128:131], v[72:79], v14
    v_exp_f32 v83, v83
    v_exp_f32 v84, v84
    v_exp_f32 v85, v85
    v_exp_f32 v86, v86
    ds_read_b128 v[28:31], v141 offset:31488
    v_mfma_f32_32x32x16_bf16 v[32:47], v[16:19], v[4:7], v[32:47]
    v_exp_f32 v87, v87
    v_exp_f32 v88, v88
    v_exp_f32 v89, v89
    v_exp_f32 v90, v90
    ds_read_b128 v[160:163], v138 offset:32512
    v_smfmac_f32_32x32x32_bf16 v[112:127], v[24:27], v[80:87], v14
    v_exp_f32 v91, v91
    v_exp_f32 v92, v92
    v_exp_f32 v93, v93
    v_exp_f32 v94, v94
    ds_read_b128 v[24:27], v140 offset:31488
    v_mfma_f32_32x32x16_bf16 v[48:63], v[16:19], v[8:11], v[48:63]
    v_exp_f32 v95, v95
    v_exp_f32 v32, v32
    v_exp_f32 v33, v33
    v_exp_f32 v34, v34
    v_smfmac_f32_32x32x32_bf16 v[112:127], v[128:131], v[88:95], v14
    v_exp_f32 v35, v35
    v_exp_f32 v36, v36
    v_exp_f32 v37, v37
    v_exp_f32 v38, v38
    v_mfma_f32_32x32x4_2b_bf16 v[64:95], v[20:21], v[12:13], 0 cbsz:1 abid:1
    v_exp_f32 v39, v39
    v_exp_f32 v40, v40
    v_exp_f32 v41, v41
    v_exp_f32 v42, v42
    v_exp_f32 v43, v43
    v_exp_f32 v44, v44
    v_exp_f32 v45, v45
    v_exp_f32 v46, v46
    s_waitcnt lgkmcnt(0)
    v_smfmac_f32_32x32x32_bf16 v[96:111], v[24:27], v[32:39], v14
    v_exp_f32 v47, v47
    v_exp_f32 v48, v48
    v_exp_f32 v49, v49
    v_exp_f32 v50, v50
    v_smfmac_f32_32x32x32_bf16 v[96:111], v[28:31], v[40:47], v14
    v_exp_f32 v51, v51
    v_exp_f32 v52, v52
    v_exp_f32 v53, v53
    v_exp_f32 v54, v54
    ds_read_b128 v[128:131], v143 offset:31488
    v_mfma_f32_32x32x16_bf16 v[64:79], v[160:163], v[4:7], v[64:79]
    v_exp_f32 v55, v55
    s_setprio 2
    v_exp_f32 v56, v56
    v_exp_f32 v57, v57
    v_exp_f32 v58, v58
    ds_read_b128 v[16:19], v138 offset:41984
    v_smfmac_f32_32x32x32_bf16 v[112:127], v[24:27], v[48:55], v14
    v_exp_f32 v59, v59
    v_exp_f32 v60, v60
    v_exp_f32 v61, v61
    v_exp_f32 v62, v62
    ds_read_b128 v[24:27], v142 offset:31488
    v_mfma_f32_32x32x16_bf16 v[80:95], v[160:163], v[8:11], v[80:95]
    v_exp_f32 v63, v63
    v_exp_f32 v64, v64
    v_exp_f32 v65, v65
    v_exp_f32 v66, v66
    v_smfmac_f32_32x32x32_bf16 v[112:127], v[28:31], v[56:63], v14
    v_exp_f32 v67, v67
    v_exp_f32 v68, v68
    v_exp_f32 v69, v69
    v_exp_f32 v70, v70
    v_mfma_f32_32x32x4_2b_bf16 v[32:63], v[22:23], v[12:13], 0 cbsz:1 abid:0
    v_exp_f32 v71, v71
    v_exp_f32 v72, v72
    v_exp_f32 v73, v73
    v_exp_f32 v74, v74
    v_exp_f32 v75, v75
    v_exp_f32 v76, v76
    v_exp_f32 v77, v77
    v_exp_f32 v78, v78
    s_waitcnt lgkmcnt(0)
    v_smfmac_f32_32x32x32_bf16 v[96:111], v[24:27], v[64:71], v14
    v_exp_f32 v79, v79
    v_exp_f32 v80, v80
    v_exp_f32 v81, v81
    v_exp_f32 v82, v82
    ds_read_b64 v[20:21], v139 offset:52480
    v_smfmac_f32_32x32x32_bf16 v[96:111], v[128:131], v[72:79], v14
    v_exp_f32 v83, v83
    v_exp_f32 v84, v84
    v_exp_f32 v85, v85
    v_exp_f32 v86, v86
    ds_read_b128 v[28:31], v141 offset:41984
    v_mfma_f32_32x32x16_bf16 v[32:47], v[16:19], v[4:7], v[32:47]
    v_exp_f32 v87, v87
    v_exp_f32 v88, v88
    v_exp_f32 v89, v89
    v_exp_f32 v90, v90
    ds_read_b128 v[160:163], v138 offset:43008
    v_smfmac_f32_32x32x32_bf16 v[112:127], v[24:27], v[80:87], v14
    v_exp_f32 v91, v91
    v_exp_f32 v92, v92
    v_exp_f32 v93, v93
    v_exp_f32 v94, v94
    ds_read_b128 v[24:27], v140 offset:41984
    v_mfma_f32_32x32x16_bf16 v[48:63], v[16:19], v[8:11], v[48:63]
    v_exp_f32 v95, v95
    v_exp_f32 v32, v32
    v_exp_f32 v33, v33
    v_exp_f32 v34, v34
    v_smfmac_f32_32x32x32_bf16 v[112:127], v[128:131], v[88:95], v14
    v_exp_f32 v35, v35
    v_exp_f32 v36, v36
    v_exp_f32 v37, v37
    v_exp_f32 v38, v38
    v_mfma_f32_32x32x4_2b_bf16 v[64:95], v[22:23], v[12:13], 0 cbsz:1 abid:1
    v_exp_f32 v39, v39
    v_exp_f32 v40, v40
    v_exp_f32 v41, v41
    v_exp_f32 v42, v42
    v_exp_f32 v43, v43
    v_exp_f32 v44, v44
    v_exp_f32 v45, v45
    v_exp_f32 v46, v46
    s_waitcnt lgkmcnt(0)
    v_smfmac_f32_32x32x32_bf16 v[96:111], v[24:27], v[32:39], v14
    v_exp_f32 v47, v47
    v_exp_f32 v48, v48
    v_exp_f32 v49, v49
    v_exp_f32 v50, v50
    v_smfmac_f32_32x32x32_bf16 v[96:111], v[28:31], v[40:47], v14
    v_exp_f32 v51, v51
    v_exp_f32 v52, v52
    v_exp_f32 v53, v53
    v_exp_f32 v54, v54
    ds_read_b128 v[128:131], v143 offset:41984
    v_mfma_f32_32x32x16_bf16 v[64:79], v[160:163], v[4:7], v[64:79]
    v_exp_f32 v55, v55
    v_exp_f32 v56, v56
    v_exp_f32 v57, v57
    v_exp_f32 v58, v58
    ds_read_b128 v[16:19], v138 offset:52480
    v_smfmac_f32_32x32x32_bf16 v[112:127], v[24:27], v[48:55], v14
    v_exp_f32 v59, v59
    v_exp_f32 v60, v60
    v_exp_f32 v61, v61
    v_exp_f32 v62, v62
    ds_read_b128 v[24:27], v142 offset:41984
    v_mfma_f32_32x32x16_bf16 v[80:95], v[160:163], v[8:11], v[80:95]
    v_exp_f32 v63, v63
    v_exp_f32 v64, v64
    v_exp_f32 v65, v65
    v_exp_f32 v66, v66
    v_smfmac_f32_32x32x32_bf16 v[112:127], v[28:31], v[56:63], v14
    v_exp_f32 v67, v67
    v_exp_f32 v68, v68
    v_exp_f32 v69, v69
    v_exp_f32 v70, v70
    v_mfma_f32_32x32x4_2b_bf16 v[32:63], v[20:21], v[12:13], 0 cbsz:1 abid:0
    v_exp_f32 v71, v71
    v_exp_f32 v72, v72
    v_exp_f32 v73, v73
    v_exp_f32 v74, v74
    v_exp_f32 v75, v75
    v_exp_f32 v76, v76
    v_exp_f32 v77, v77
    v_exp_f32 v78, v78
    s_waitcnt lgkmcnt(0)
    v_smfmac_f32_32x32x32_bf16 v[96:111], v[24:27], v[64:71], v14
    v_exp_f32 v79, v79
    v_exp_f32 v80, v80
    v_exp_f32 v81, v81
    v_exp_f32 v82, v82
    ds_read_b64 v[22:23], v145 offset:0
    v_smfmac_f32_32x32x32_bf16 v[96:111], v[128:131], v[72:79], v14
    v_exp_f32 v83, v83
    v_exp_f32 v84, v84
    v_exp_f32 v85, v85
    v_exp_f32 v86, v86
    ds_read_b128 v[28:31], v141 offset:52480
    v_mfma_f32_32x32x16_bf16 v[32:47], v[16:19], v[4:7], v[32:47]
    v_exp_f32 v87, v87
    s_setprio 1
    v_exp_f32 v88, v88
    v_exp_f32 v89, v89
    v_exp_f32 v90, v90
    ds_read_b128 v[160:163], v138 offset:53504
    v_smfmac_f32_32x32x32_bf16 v[112:127], v[24:27], v[80:87], v14
    v_exp_f32 v91, v91
    v_exp_f32 v92, v92
    v_exp_f32 v93, v93
    v_exp_f32 v94, v94
    ds_read_b128 v[24:27], v140 offset:52480
    v_mfma_f32_32x32x16_bf16 v[48:63], v[16:19], v[8:11], v[48:63]
    v_exp_f32 v95, v95
    v_exp_f32 v32, v32
    v_exp_f32 v33, v33
    v_exp_f32 v34, v34
    v_smfmac_f32_32x32x32_bf16 v[112:127], v[128:131], v[88:95], v14
    v_exp_f32 v35, v35
    v_exp_f32 v36, v36
    v_exp_f32 v37, v37
    v_exp_f32 v38, v38
    v_mfma_f32_32x32x4_2b_bf16 v[64:95], v[20:21], v[12:13], 0 cbsz:1 abid:1
    v_exp_f32 v39, v39
    v_exp_f32 v40, v40
    v_exp_f32 v41, v41
    v_exp_f32 v42, v42
    v_exp_f32 v43, v43
    v_exp_f32 v44, v44
    v_exp_f32 v45, v45
    v_exp_f32 v46, v46
    s_waitcnt lgkmcnt(0)
    v_smfmac_f32_32x32x32_bf16 v[96:111], v[24:27], v[32:39], v14
    v_exp_f32 v47, v47
    v_exp_f32 v48, v48
    v_exp_f32 v49, v49
    v_exp_f32 v50, v50
    v_smfmac_f32_32x32x32_bf16 v[96:111], v[28:31], v[40:47], v14
    v_exp_f32 v51, v51
    v_exp_f32 v52, v52
    v_exp_f32 v53, v53
    v_exp_f32 v54, v54
    ds_read_b128 v[128:131], v143 offset:52480
    v_mfma_f32_32x32x16_bf16 v[64:79], v[160:163], v[4:7], v[64:79]
    v_exp_f32 v55, v55
    v_exp_f32 v56, v56
    v_exp_f32 v57, v57
    v_exp_f32 v58, v58
    ds_read_b128 v[16:19], v144 offset:0
    v_smfmac_f32_32x32x32_bf16 v[112:127], v[24:27], v[48:55], v14
    v_exp_f32 v59, v59
    v_exp_f32 v60, v60
    v_exp_f32 v61, v61
    v_exp_f32 v62, v62
    s_setprio 0
    ds_read_b128 v[24:27], v142 offset:52480
    v_mfma_f32_32x32x16_bf16 v[80:95], v[160:163], v[8:11], v[80:95]
    v_exp_f32 v63, v63
    v_exp_f32 v64, v64
    v_exp_f32 v65, v65
    v_exp_f32 v66, v66
    v_smfmac_f32_32x32x32_bf16 v[112:127], v[28:31], v[56:63], v14
    v_exp_f32 v67, v67
    v_exp_f32 v68, v68
    v_exp_f32 v69, v69
    v_exp_f32 v70, v70
    v_mfma_f32_32x32x4_2b_bf16 v[32:63], v[22:23], v[12:13], 0 cbsz:1 abid:0
    v_exp_f32 v71, v71
    v_exp_f32 v72, v72
    v_exp_f32 v73, v73
    v_exp_f32 v74, v74
    v_exp_f32 v75, v75
    v_exp_f32 v76, v76
    v_exp_f32 v77, v77
    v_exp_f32 v78, v78
    s_waitcnt lgkmcnt(0)
    v_smfmac_f32_32x32x32_bf16 v[96:111], v[24:27], v[64:71], v14
    v_exp_f32 v79, v79
    v_exp_f32 v80, v80
    v_exp_f32 v81, v81
    v_exp_f32 v82, v82
    s_barrier
    s_setprio 3
    ds_read_b64 v[20:21], v145 offset:10496
    v_smfmac_f32_32x32x32_bf16 v[96:111], v[128:131], v[72:79], v14
    v_exp_f32 v83, v83
    v_exp_f32 v84, v84
    v_exp_f32 v85, v85
    v_exp_f32 v86, v86
    ds_read_b128 v[28:31], v147 offset:0
    v_mfma_f32_32x32x16_bf16 v[32:47], v[16:19], v[4:7], v[32:47]
    v_exp_f32 v87, v87
    v_exp_f32 v88, v88
    v_exp_f32 v89, v89
    v_exp_f32 v90, v90
    ds_read_b128 v[160:163], v144 offset:1024
    v_smfmac_f32_32x32x32_bf16 v[112:127], v[24:27], v[80:87], v14
    v_exp_f32 v91, v91
    v_exp_f32 v92, v92
    v_exp_f32 v93, v93
    v_exp_f32 v94, v94
    ds_read_b128 v[24:27], v146 offset:0
    v_mfma_f32_32x32x16_bf16 v[48:63], v[16:19], v[8:11], v[48:63]
    v_exp_f32 v95, v95
    v_exp_f32 v32, v32
    v_exp_f32 v33, v33
    v_exp_f32 v34, v34
    v_smfmac_f32_32x32x32_bf16 v[112:127], v[128:131], v[88:95], v14
    v_exp_f32 v35, v35
    v_exp_f32 v36, v36
    v_exp_f32 v37, v37
    v_exp_f32 v38, v38
    v_mfma_f32_32x32x4_2b_bf16 v[64:95], v[22:23], v[12:13], 0 cbsz:1 abid:1
    v_exp_f32 v39, v39
    v_exp_f32 v40, v40
    v_exp_f32 v41, v41
    v_exp_f32 v42, v42
    v_exp_f32 v43, v43
    v_exp_f32 v44, v44
    v_exp_f32 v45, v45
    v_exp_f32 v46, v46
    s_waitcnt lgkmcnt(0)
    v_smfmac_f32_32x32x32_bf16 v[96:111], v[24:27], v[32:39], v14
    v_exp_f32 v47, v47
    v_exp_f32 v48, v48
    v_exp_f32 v49, v49
    v_exp_f32 v50, v50
    v_smfmac_f32_32x32x32_bf16 v[96:111], v[28:31], v[40:47], v14
    v_exp_f32 v51, v51
    v_exp_f32 v52, v52
    v_exp_f32 v53, v53
    v_exp_f32 v54, v54
    ds_read_b128 v[128:131], v149 offset:0
    v_mfma_f32_32x32x16_bf16 v[64:79], v[160:163], v[4:7], v[64:79]
    v_exp_f32 v55, v55
    v_exp_f32 v56, v56
    v_exp_f32 v57, v57
    v_exp_f32 v58, v58
    ds_read_b128 v[16:19], v144 offset:10496
    v_smfmac_f32_32x32x32_bf16 v[112:127], v[24:27], v[48:55], v14
    v_exp_f32 v59, v59
    v_exp_f32 v60, v60
    v_exp_f32 v61, v61
    v_exp_f32 v62, v62
    ds_read_b128 v[24:27], v148 offset:0
    v_mfma_f32_32x32x16_bf16 v[80:95], v[160:163], v[8:11], v[80:95]
    v_exp_f32 v63, v63
    v_exp_f32 v64, v64
    v_exp_f32 v65, v65
    v_exp_f32 v66, v66
    v_smfmac_f32_32x32x32_bf16 v[112:127], v[28:31], v[56:63], v14
    v_exp_f32 v67, v67
    v_exp_f32 v68, v68
    v_exp_f32 v69, v69
    v_exp_f32 v70, v70
    v_mfma_f32_32x32x4_2b_bf16 v[32:63], v[20:21], v[12:13], 0 cbsz:1 abid:0
    v_exp_f32 v71, v71
    v_exp_f32 v72, v72
    v_exp_f32 v73, v73
    v_exp_f32 v74, v74
    v_exp_f32 v75, v75
    v_exp_f32 v76, v76
    v_exp_f32 v77, v77
    v_exp_f32 v78, v78
    s_waitcnt lgkmcnt(0)
    v_smfmac_f32_32x32x32_bf16 v[96:111], v[24:27], v[64:71], v14
    v_exp_f32 v79, v79
    v_exp_f32 v80, v80
    v_exp_f32 v81, v81
    v_exp_f32 v82, v82
    ds_read_b64 v[22:23], v145 offset:20992
    v_smfmac_f32_32x32x32_bf16 v[96:111], v[128:131], v[72:79], v14
    v_exp_f32 v83, v83
    v_exp_f32 v84, v84
    v_exp_f32 v85, v85
    v_exp_f32 v86, v86
    ds_read_b128 v[28:31], v147 offset:10496
    v_mfma_f32_32x32x16_bf16 v[32:47], v[16:19], v[4:7], v[32:47]
    v_exp_f32 v87, v87
    v_exp_f32 v88, v88
    v_exp_f32 v89, v89
    v_exp_f32 v90, v90
    ds_read_b128 v[160:163], v144 offset:11520
    v_smfmac_f32_32x32x32_bf16 v[112:127], v[24:27], v[80:87], v14
    v_exp_f32 v91, v91
    v_exp_f32 v92, v92
    v_exp_f32 v93, v93
    v_exp_f32 v94, v94
    ds_read_b128 v[24:27], v146 offset:10496
    v_mfma_f32_32x32x16_bf16 v[48:63], v[16:19], v[8:11], v[48:63]
    v_exp_f32 v95, v95
    v_exp_f32 v32, v32
    v_exp_f32 v33, v33
    v_exp_f32 v34, v34
    v_smfmac_f32_32x32x32_bf16 v[112:127], v[128:131], v[88:95], v14
    v_exp_f32 v35, v35
    v_exp_f32 v36, v36
    v_exp_f32 v37, v37
    v_exp_f32 v38, v38
    v_mfma_f32_32x32x4_2b_bf16 v[64:95], v[20:21], v[12:13], 0 cbsz:1 abid:1
    v_exp_f32 v39, v39
    v_exp_f32 v40, v40
    v_exp_f32 v41, v41
    v_exp_f32 v42, v42
    v_exp_f32 v43, v43
    v_exp_f32 v44, v44
    v_exp_f32 v45, v45
    v_exp_f32 v46, v46
    s_waitcnt lgkmcnt(0)
    v_smfmac_f32_32x32x32_bf16 v[96:111], v[24:27], v[32:39], v14
    v_exp_f32 v47, v47
    v_exp_f32 v48, v48
    v_exp_f32 v49, v49
    v_exp_f32 v50, v50
    v_smfmac_f32_32x32x32_bf16 v[96:111], v[28:31], v[40:47], v14
    v_exp_f32 v51, v51
    v_exp_f32 v52, v52
    v_exp_f32 v53, v53
    v_exp_f32 v54, v54
    ds_read_b128 v[128:131], v149 offset:10496
    v_mfma_f32_32x32x16_bf16 v[64:79], v[160:163], v[4:7], v[64:79]
    v_exp_f32 v55, v55
    v_exp_f32 v56, v56
    v_exp_f32 v57, v57
    v_exp_f32 v58, v58
    ds_read_b128 v[16:19], v144 offset:20992
    v_smfmac_f32_32x32x32_bf16 v[112:127], v[24:27], v[48:55], v14
    v_exp_f32 v59, v59
    v_exp_f32 v60, v60
L_pad4:
    s_cbranch_execz L_padret
    v_exp_f32 v61, v61
    v_exp_f32 v62, v62
    ds_read_b128 v[24:27], v148 offset:10496
    v_mfma_f32_32x32x16_bf16 v[80:95], v[160:163], v[8:11], v[80:95]
    v_exp_f32 v63, v63
    v_exp_f32 v64, v64
    v_exp_f32 v65, v65
    v_exp_f32 v66, v66
    v_smfmac_f32_32x32x32_bf16 v[112:127], v[28:31], v[56:63], v14
    ds_read_b128 v[160:163], v144 offset:22016
    ds_read_b64 v[20:21], v151 offset:20992
    v_exp_f32 v67, v67
    v_exp_f32 v68, v68
    v_exp_f32 v69, v69
    v_exp_f32 v70, v70
    v_mfma_f32_32x32x4_2b_bf16 v[32:63], v[22:23], v[2:3], 0
    v_exp_f32 v71, v71
    v_exp_f32 v72, v72
    v_exp_f32 v73, v73
    v_exp_f32 v74, v74
    v_exp_f32 v75, v75
    v_exp_f32 v76, v76
    v_exp_f32 v77, v77
    s_setprio 2
    v_exp_f32 v78, v78
    s_waitcnt lgkmcnt(0)
    v_smfmac_f32_32x32x32_bf16 v[96:111], v[24:27], v[64:71], v14
    v_exp_f32 v79, v79
    v_exp_f32 v80, v80
    v_exp_f32 v81, v81
    v_exp_f32 v82, v82
    ds_read_b128 v[164:167], v148 offset:20992
    v_smfmac_f32_32x32x32_bf16 v[96:111], v[128:131], v[72:79], v14
    v_exp_f32 v83, v83
    v_exp_f32 v84, v84
    v_exp_f32 v85, v85
    v_exp_f32 v86, v86
    ds_read_b128 v[28:31], v147 offset:20992
    v_mfma_f32_32x32x16_bf16 v[32:47], v[16:19], v[4:7], v[32:47]
    v_exp_f32 v87, v87
    v_exp_f32 v88, v88
    v_exp_f32 v89, v89
    v_exp_f32 v90, v90
    ds_read_b128 v[16:19], v150 offset:20992
    v_smfmac_f32_32x32x32_bf16 v[112:127], v[24:27], v[80:87], v14
    v_exp_f32 v91, v91
    v_exp_f32 v92, v92
    v_exp_f32 v93, v93
    v_exp_f32 v94, v94
    ds_read_b128 v[24:27], v146 offset:20992
    v_mfma_f32_32x32x16_bf16 v[48:63], v[160:163], v[4:7], v[48:63]
    v_exp_f32 v95, v95
    v_exp_f32 v32, v32
    v_exp_f32 v33, v33
    v_exp_f32 v34, v34
    v_smfmac_f32_32x32x32_bf16 v[112:127], v[128:131], v[88:95], v14
    ds_read_b128 v[160:163], v150 offset:22016
    ds_read_b128 v[128:131], v149 offset:20992
    v_exp_f32 v35, v35
    v_exp_f32 v36, v36
    v_exp_f32 v37, v37
    v_exp_f32 v38, v38
    v_mfma_f32_32x32x4_2b_bf16 v[64:95], v[20:21], v[2:3], 0
    v_exp_f32 v39, v39
    v_exp_f32 v40, v40
    v_exp_f32 v41, v41
    v_exp_f32 v42, v42
    v_exp_f32 v43, v43
    v_exp_f32 v44, v44
    v_exp_f32 v45, v45
    v_exp_f32 v46, v46
    s_waitcnt lgkmcnt(0)
    v_smfmac_f32_32x32x32_bf16 v[96:111], v[24:27], v[32:39], v14
    v_exp_f32 v47, v47
    v_exp_f32 v48, v48
    v_exp_f32 v49, v49
    v_exp_f32 v50, v50
    ds_read_b128 v[24:27], v152 offset:20992
    ds_write_b128 v156, v[112:115] offset:0
    v_smfmac_f32_32x32x32_bf16 v[96:111], v[28:31], v[40:47], v14
    v_exp_f32 v51, v51
    v_exp_f32 v52, v52
    v_exp_f32 v53, v53
    v_exp_f32 v54, v54
    ds_read_b128 v[28:31], v153 offset:20992
    ds_write_b128 v156, v[116:119] offset:1024
    v_mfma_f32_32x32x16_bf16 v[64:79], v[16:19], v[4:7], v[64:79]
    v_exp_f32 v55, v55
    v_exp_f32 v56, v56
    v_exp_f32 v57, v57
    v_exp_f32 v58, v58
    ds_write_b128 v156, v[120:123] offset:2048
    v_smfmac_f32_32x32x32_bf16 v[96:111], v[164:167], v[48:55], v14
    v_exp_f32 v59, v59
    v_exp_f32 v60, v60
    s_setprio 1
    v_exp_f32 v61, v61
    v_exp_f32 v62, v62
    ds_read_b128 v[164:167], v154 offset:20992
    v_mfma_f32_32x32x16_bf16 v[80:95], v[160:163], v[4:7], v[80:95]
    v_exp_f32 v63, v63
    v_exp_f32 v64, v64
    v_exp_f32 v65, v65
    v_exp_f32 v66, v66
    v_smfmac_f32_32x32x32_bf16 v[96:111], v[128:131], v[56:63], v14
    ds_read_b128 v[128:131], v155 offset:20992
    v_exp_f32 v67, v67
    v_exp_f32 v68, v68
    v_exp_f32 v69, v69
    v_exp_f32 v70, v70
    v_exp_f32 v71, v71
    v_exp_f32 v72, v72
    v_exp_f32 v73, v73
    v_exp_f32 v74, v74
    v_exp_f32 v75, v75
    v_exp_f32 v76, v76
    v_exp_f32 v77, v77
    v_exp_f32 v78, v78
    s_waitcnt lgkmcnt(0)
    v_smfmac_f32_32x32x32_bf16 v[96:111], v[24:27], v[64:71], v14
    v_exp_f32 v79, v79
    v_exp_f32 v80, v80
    v_exp_f32 v81, v81
    v_exp_f32 v82, v82
    s_setprio 0
    v_smfmac_f32_32x32x32_bf16 v[96:111], v[28:31], v[72:79], v14
    v_exp_f32 v83, v83
    v_exp_f32 v84, v84
    v_exp_f32 v85, v85
    v_exp_f32 v86, v86
    v_exp_f32 v87, v87
    v_exp_f32 v88, v88
    v_exp_f32 v89, v89
    v_exp_f32 v90, v90
    v_smfmac_f32_32x32x32_bf16 v[96:111], v[164:167], v[80:87], v14
    v_exp_f32 v91, v91
    v_exp_f32 v92, v92
    v_exp_f32 v93, v93
    v_exp_f32 v94, v94
    s_barrier
    ds_read_b128 v[112:115], v157 offset:0
    ds_read_b128 v[116:119], v157 offset:1024
    ds_read_b128 v[120:123], v157 offset:2048
    v_exp_f32 v95, v95
    s_nop 1
    v_smfmac_f32_32x32x32_bf16 v[96:111], v[128:131], v[88:95], v14
    s_nop 10
    s_waitcnt lgkmcnt(0)
L_norm:
    v_add_f32 v48, v104, v120
    v_add_f32 v49, v104, v120
    v_pk_add_f32 v[96:97], v[96:97], v[112:113]
    v_pk_add_f32 v[98:99], v[98:99], v[114:115]
    v_permlane32_swap_b32 v48, v49
    v_pk_add_f32 v[100:101], v[100:101], v[116:117]
    v_rcp_f32 v50, v49
    v_cmp_nle_f32 vcc, s60, v49
    v_cmp_nge_f32 s[50:51], s61, v49
    v_pk_add_f32 v[102:103], v[102:103], v[118:119]
    s_or_b64 s[50:51], vcc, s[50:51]
    v_pk_add_f32 v[104:105], v[104:105], v[120:121]
    v_cndmask_b32 v50, v50, -1, s[50:51]
    v_pk_add_f32 v[106:107], v[106:107], v[122:123]
    v_pk_mul_f32 v[32:33], v[96:97], v[50:51] op_sel_hi:[1,0]
    v_pk_mul_f32 v[34:35], v[98:99], v[50:51] op_sel_hi:[1,0]
    v_pk_mul_f32 v[36:37], v[100:101], v[50:51] op_sel_hi:[1,0]
    v_pk_mul_f32 v[38:39], v[102:103], v[50:51] op_sel_hi:[1,0]
    v_cvt_pk_bf16_f32 v64, v32, v33
    v_cvt_pk_bf16_f32 v65, v34, v35
    v_cvt_pk_bf16_f32 v66, v36, v37
    v_cvt_pk_bf16_f32 v67, v38, v39
    buffer_store_dwordx4 v[64:67], v1, s[24:27], s53 offen sc1
    v_pk_mul_f32 v[40:41], v[104:105], v[50:51] op_sel_hi:[1,0]
    v_pk_mul_f32 v[42:43], v[106:107], v[50:51] op_sel_hi:[1,0]
    v_cvt_pk_bf16_f32 v68, v40, v41
    v_cvt_pk_bf16_f32 v69, v42, v43
    buffer_store_dwordx2 v[68:69], v158, s[24:27], s54 offen sc1
    v_fma_f32 v49, v96, 0, v49
    v_fma_f32 v49, v97, 0, v49
    v_fma_f32 v49, v98, 0, v49
    v_fma_f32 v49, v99, 0, v49
    v_fma_f32 v49, v100, 0, v49
    v_fma_f32 v49, v101, 0, v49
    v_fma_f32 v49, v102, 0, v49
    v_fma_f32 v49, v103, 0, v49
    v_fma_f32 v49, v104, 0, v49
    v_fma_f32 v49, v105, 0, v49
    v_fma_f32 v49, v106, 0, v49
    v_fma_f32 v49, v107, 0, v49
    v_cmp_nle_f32 vcc, s60, v49
    v_cmp_nge_f32 s[50:51], s61, v49
    s_cmp_lg_u32 s56, 0
    s_cbranch_scc1 L_phase3
    s_or_b64 vcc, vcc, s[50:51]
    s_cbranch_scc1 L_slow
L_phase3:
    s_cmp_eq_u32 s45, 0
    s_cbranch_scc1 L_p3w
    s_lshl2_add_u32 s47, s40, 127232
    v_mov_b32 v2, s47
    s_waitcnt vmcnt(0)
    ds_write_b32 v2, v14
    s_waitcnt lgkmcnt(0)
    s_endpgm
L_p3w:
    s_load_dwordx2 s[32:33], s[0:1], 24
    s_and_b32 s41, s2, 7
    s_lshr_b32 s47, s2, 6
    s_lshl2_add_u32 s41, s41, s47
    s_bfe_u32 s42, s2, 0x30003
    s_lshr_b32 s47, s46, 1
    s_lshl1_add_u32 s48, s41, s47
    s_mul_i32 s48, s48, 40960
    s_add_u32 s48, s48, 10485760
    s_and_b32 s47, s46, 1
    s_lshl_b32 s47, s47, 4
    v_and_b32 v2, 15, v0
    v_lshrrev_b32 v3, 4, v0
    v_add_u32 v5, s47, v2
    v_lshlrev_b32 v4, 9, v3
    v_lshl_add_u32 v7, v5, 3, v4
    v_add_u32 v7, 0x1000, v7
    v_lshl_add_u32 v4, v5, 4, v4
    s_lshl2_add_u32 s47, s41, s46
    s_lshl_b32 s47, s47, 4
    v_add_u32 v5, s47, v2
    v_mul_u32_u24 v5, 1280, v5
    s_mul_i32 s47, s42, 160
    v_add_u32 v5, s47, v5
    v_lshl_add_u32 v6, v3, 3, v5
    v_lshl_add_u32 v5, v3, 4, v5
    s_and_b32 s47, s42, 1
    s_lshl_b32 s49, s47, 5
    s_lshl_b32 s47, s47, 7
    v_add_u32 v5, s49, v5
    v_subrev_u32 v6, s47, v6
    v_mov_b32 v2, 126976
    s_mov_b32 s55, 0
    s_mov_b32 s54, 0
    s_mov_b64 s[4:5], 0
    s_mov_b64 s[6:7], 0
    s_mov_b64 s[8:9], -1
    s_mov_b64 s[10:11], -1
    s_mov_b32 s34, 2621440
    s_mov_b32 s35, s27
    s_branch L_p3b
L_retry:
    s_lshl_b32 s47, s2, 9
    s_add_u32 s47, s47, 14057536
    s_add_u32 s14, s24, s47
    s_addc_u32 s15, s25, 0
    s_mov_b32 s63, 131072
L_p2:
    s_load_dwordx8 s[4:11], s[14:15], 0 glc
    s_load_dwordx8 s[16:23], s[14:15], 128 glc
L_pc2:
    s_sub_u32 s63, s63, 1
    s_cbranch_scc1 L_pd2
    s_waitcnt lgkmcnt(0)
    s_and_b64 s[4:5], s[4:5], s[16:17]
    s_and_b64 s[6:7], s[6:7], s[18:19]
    s_and_b64 s[8:9], s[8:9], s[20:21]
    s_and_b64 s[10:11], s[10:11], s[22:23]
    s_and_b64 s[4:5], s[4:5], s[6:7]
    s_and_b64 s[8:9], s[8:9], s[10:11]
    s_and_b64 s[4:5], s[4:5], s[8:9]
    s_and_b32 s4, s4, s5
    s_cmp_eq_u32 s4, 0
    s_cbranch_scc1 L_p2
L_pd2:
    s_mov_b32 s63, 131072
L_p3:
    s_load_dwordx8 s[4:11], s[14:15], 256 glc
    s_load_dwordx8 s[16:23], s[14:15], 384 glc
L_pc3:
    s_sub_u32 s63, s63, 1
    s_cbranch_scc1 L_pd3
    s_waitcnt lgkmcnt(0)
    s_and_b64 s[4:5], s[4:5], s[16:17]
    s_and_b64 s[6:7], s[6:7], s[18:19]
    s_and_b64 s[8:9], s[8:9], s[20:21]
    s_and_b64 s[10:11], s[10:11], s[22:23]
    s_and_b64 s[4:5], s[4:5], s[6:7]
    s_and_b64 s[8:9], s[8:9], s[10:11]
    s_and_b64 s[4:5], s[4:5], s[8:9]
    s_and_b32 s4, s4, s5
    s_cmp_eq_u32 s4, 0
    s_cbranch_scc1 L_p3
L_pd3:
    s_mov_b32 s54, 1
    s_mov_b32 s55, 0
    s_mov_b32 s62, 0
    s_mov_b64 s[4:5], 0
    s_mov_b64 s[6:7], 0
    s_mov_b64 s[8:9], -1
    s_mov_b64 s[10:11], -1
    s_waitcnt vmcnt(0)
    s_branch L_again
L_x1:
    s_cmp_eq_u32 s9, 0
    s_waitcnt lgkmcnt(5)
    s_cbranch_scc1 L_nx1
    s_mov_b32 s63, 131072
L_p4:
    ds_read_b32 v3, v2
L_pc4:
    s_sub_u32 s63, s63, 1
    s_cbranch_scc1 L_pd4
    s_waitcnt lgkmcnt(0)
    v_readfirstlane_b32 s47, v3
    s_andn2_b32 s50, s47, s55
    s_cmp_eq_u32 s50, 0
    s_cbranch_scc1 L_p4
L_pd4:
    v_readfirstlane_b32 s47, v3
    s_andn2_b32 s50, s47, s55
    s_cselect_b32 s9, 0, 2.0
    s_ff1_i32_b32 s5, s50
    v_bfi_b32 v4, 2.0, s9, v4
    v_bfi_b32 v7, 2.0, s9, v7
    s_bitset1_b32 s55, s5
    s_mul_i32 s56, s5, 10240
    s_add_u32 s56, s56, s48
    s_add_u32 s57, s56, 4096
    buffer_load_dwordx4 v[28:31], v4, s[24:27], s56 offen offset:0 sc1
    buffer_load_dwordx4 v[32:35], v4, s[24:27], s56 offen offset:2048 sc1
    buffer_load_dwordx4 v[36:39], v4, s[24:27], s57 offen offset:0 sc1
    buffer_load_dwordx4 v[40:43], v4, s[24:27], s57 offen offset:2048 sc1
    buffer_load_dwordx2 v[44:45], v7, s[24:27], s57 offen offset:0 sc1
    buffer_load_dwordx2 v[46:47], v7, s[24:27], s57 offen offset:256 sc1
    s_mul_i32 s53, s5, 25600
    v_add_u32 v0, s53, v1
    ds_read_b128 v[68:71], v0 offset:0
    ds_read_b128 v[72:75], v0 offset:1024
    ds_read_b128 v[76:79], v0 offset:2048
    ds_read_b128 v[80:83], v0 offset:3072
    ds_read_b128 v[84:87], v0 offset:4096
    ds_read_b128 v[48:51], v0 offset:5120
    ds_read_b128 v[52:55], v0 offset:6144
    ds_read_b128 v[56:59], v0 offset:7168
    ds_read_b128 v[60:63], v0 offset:8192
    ds_read_b128 v[64:67], v0 offset:9216
    s_andn2_b32 s50, s47, s55
    s_cbranch_scc1 L_nx1
    s_waitcnt vmcnt(5)
L_rr1:
    ds_read_b32 v3, v2
    s_waitcnt lgkmcnt(0)
L_nx1:
    v_readfirstlane_b32 s47, v3
    s_andn2_b32 s50, s47, s55
    s_cselect_b32 s10, 0, 2.0
    s_ff1_i32_b32 s6, s50
    v_bfi_b32 v4, 2.0, s10, v4
    v_bfi_b32 v7, 2.0, s10, v7
    s_bitset1_b32 s55, s6
    s_mul_i32 s56, s6, 10240
    s_add_u32 s56, s56, s48
    s_add_u32 s57, s56, 4096
    buffer_load_dwordx4 v[8:11], v4, s[24:27], s56 offen offset:0 sc1
    buffer_load_dwordx4 v[12:15], v4, s[24:27], s56 offen offset:2048 sc1
    buffer_load_dwordx4 v[16:19], v4, s[24:27], s57 offen offset:0 sc1
    buffer_load_dwordx4 v[20:23], v4, s[24:27], s57 offen offset:2048 sc1
    buffer_load_dwordx2 v[24:25], v7, s[24:27], s57 offen offset:0 sc1
    buffer_load_dwordx2 v[26:27], v7, s[24:27], s57 offen offset:256 sc1
    s_branch L_go1
L_x2:
    s_cmp_eq_u32 s10, 0
    s_waitcnt lgkmcnt(5)
    s_cbranch_scc1 L_nx2
    s_mov_b32 s63, 131072
L_p5:
    ds_read_b32 v3, v2
L_pc5:
    s_sub_u32 s63, s63, 1
    s_cbranch_scc1 L_pd5
    s_waitcnt lgkmcnt(0)
    v_readfirstlane_b32 s47, v3
    s_andn2_b32 s50, s47, s55
    s_cmp_eq_u32 s50, 0
    s_cbranch_scc1 L_p5
L_pd5:
    v_readfirstlane_b32 s47, v3
    s_andn2_b32 s50, s47, s55
    s_cselect_b32 s10, 0, 2.0
    s_ff1_i32_b32 s6, s50
    v_bfi_b32 v4, 2.0, s10, v4
    v_bfi_b32 v7, 2.0, s10, v7
    s_bitset1_b32 s55, s6
    s_mul_i32 s56, s6, 10240
    s_add_u32 s56, s56, s48
    s_add_u32 s57, s56, 4096
    buffer_load_dwordx4 v[8:11], v4, s[24:27], s56 offen offset:0 sc1
    buffer_load_dwordx4 v[12:15], v4, s[24:27], s56 offen offset:2048 sc1
    buffer_load_dwordx4 v[16:19], v4, s[24:27], s57 offen offset:0 sc1
    buffer_load_dwordx4 v[20:23], v4, s[24:27], s57 offen offset:2048 sc1
    buffer_load_dwordx2 v[24:25], v7, s[24:27], s57 offen offset:0 sc1
    buffer_load_dwordx2 v[26:27], v7, s[24:27], s57 offen offset:256 sc1
    s_mul_i32 s53, s6, 25600
    v_add_u32 v0, s53, v1
    ds_read_b128 v[48:51], v0 offset:0
    ds_read_b128 v[52:55], v0 offset:1024
    ds_read_b128 v[56:59], v0 offset:2048
    ds_read_b128 v[60:63], v0 offset:3072
    ds_read_b128 v[64:67], v0 offset:4096
    ds_read_b128 v[68:71], v0 offset:5120
    ds_read_b128 v[72:75], v0 offset:6144
    ds_read_b128 v[76:79], v0 offset:7168
    ds_read_b128 v[80:83], v0 offset:8192
    ds_read_b128 v[84:87], v0 offset:9216
    s_andn2_b32 s50, s47, s55
    s_cbranch_scc1 L_nx2
    s_waitcnt vmcnt(5)
L_rr2:
    ds_read_b32 v3, v2
    s_waitcnt lgkmcnt(0)
L_nx2:
    v_readfirstlane_b32 s47, v3
    s_andn2_b32 s50, s47, s55
    s_cselect_b32 s11, 0, 2.0
    s_ff1_i32_b32 s7, s50
    v_bfi_b32 v4, 2.0, s11, v4
    v_bfi_b32 v7, 2.0, s11, v7
    s_bitset1_b32 s55, s7
    s_mul_i32 s56, s7, 10240
    s_add_u32 s56, s56, s48
    s_add_u32 s57, s56, 4096
    buffer_load_dwordx4 v[28:31], v4, s[24:27], s56 offen offset:0 sc1
    buffer_load_dwordx4 v[32:35], v4, s[24:27], s56 offen offset:2048 sc1
    buffer_load_dwordx4 v[36:39], v4, s[24:27], s57 offen offset:0 sc1
    buffer_load_dwordx4 v[40:43], v4, s[24:27], s57 offen offset:2048 sc1
    buffer_load_dwordx2 v[44:45], v7, s[24:27], s57 offen offset:0 sc1
    buffer_load_dwordx2 v[46:47], v7, s[24:27], s57 offen offset:256 sc1
    s_branch L_go2
L_x3:
    s_mov_b32 s63, 131072
L_p6:
    ds_read_b32 v3, v2
L_pc6:
    s_sub_u32 s63, s63, 1
    s_cbranch_scc1 L_pd6
    s_waitcnt lgkmcnt(0)
    v_readfirstlane_b32 s47, v3
    s_andn2_b32 s50, s47, s55
    s_cmp_eq_u32 s50, 0
    s_cbranch_scc1 L_p6
L_pd6:
    v_readfirstlane_b32 s47, v3
    s_andn2_b32 s50, s47, s55
    s_cselect_b32 s11, 0, 2.0
    s_ff1_i32_b32 s7, s50
    v_bfi_b32 v4, 2.0, s11, v4
    v_bfi_b32 v7, 2.0, s11, v7
    s_bitset1_b32 s55, s7
    s_mul_i32 s56, s7, 10240
    s_add_u32 s56, s56, s48
    s_add_u32 s57, s56, 4096
    buffer_load_dwordx4 v[28:31], v4, s[24:27], s56 offen offset:0 sc1
    buffer_load_dwordx4 v[32:35], v4, s[24:27], s56 offen offset:2048 sc1
    buffer_load_dwordx4 v[36:39], v4, s[24:27], s57 offen offset:0 sc1
    buffer_load_dwordx4 v[40:43], v4, s[24:27], s57 offen offset:2048 sc1
    buffer_load_dwordx2 v[44:45], v7, s[24:27], s57 offen offset:0 sc1
    buffer_load_dwordx2 v[46:47], v7, s[24:27], s57 offen offset:256 sc1
    s_mul_i32 s53, s7, 25600
    v_add_u32 v0, s53, v1
    ds_read_b128 v[68:71], v0 offset:0
    ds_read_b128 v[72:75], v0 offset:1024
    ds_read_b128 v[76:79], v0 offset:2048
    ds_read_b128 v[80:83], v0 offset:3072
    ds_read_b128 v[84:87], v0 offset:4096
    ds_read_b128 v[48:51], v0 offset:5120
    ds_read_b128 v[52:55], v0 offset:6144
    ds_read_b128 v[56:59], v0 offset:7168
    ds_read_b128 v[60:63], v0 offset:8192
    ds_read_b128 v[64:67], v0 offset:9216
    s_branch L_go3
L_t23:
    s_cmp_eq_u32 s47, s6
    s_nop 2
    s_cbranch_scc1 L_t2
    v_swap_b32 v88, v128
    v_swap_b32 v89, v129
    v_swap_b32 v90, v130
    v_swap_b32 v91, v131
    v_swap_b32 v92, v132
    v_swap_b32 v93, v133
    v_swap_b32 v94, v134
    v_swap_b32 v95, v135
    v_swap_b32 v96, v136
    v_swap_b32 v97, v137
    v_swap_b32 v98, v138
    v_swap_b32 v99, v139
    v_swap_b32 v100, v140
    v_swap_b32 v101, v141
    v_swap_b32 v102, v142
    v_swap_b32 v103, v143
    v_swap_b32 v104, v144
    v_swap_b32 v105, v145
    v_swap_b32 v106, v146
    v_swap_b32 v107, v147
    s_branch L_t3
L_t2:
    v_swap_b32 v108, v128
    v_swap_b32 v109, v129
    v_swap_b32 v110, v130
    v_swap_b32 v111, v131
    v_swap_b32 v112, v132
    v_swap_b32 v113, v133
    v_swap_b32 v114, v134
    v_swap_b32 v115, v135
    v_swap_b32 v116, v136
    v_swap_b32 v117, v137
    v_swap_b32 v118, v138
    v_swap_b32 v119, v139
    v_swap_b32 v120, v140
    v_swap_b32 v121, v141
    v_swap_b32 v122, v142
    v_swap_b32 v123, v143
    v_swap_b32 v124, v144
    v_swap_b32 v125, v145
    v_swap_b32 v126, v146
    v_swap_b32 v127, v147
    s_branch L_t3
.p2align 12
L_slow:
    s_lshl_b32 s47, s45, 11
    s_add_u32 s47, s47, 6400
    v_subrev_u32 v150, s47, v132
    s_lshl_b32 s47, s45, 9
    s_add_u32 s47, s47, 6400
    v_subrev_u32 v151, s47, v133
    s_mul_i32 s47, s45, 2560
    s_add_u32 s47, s47, 6400
    v_subrev_u32 v28, s47, v134
    s_mov_b32 s48, 0x000fffff
    s_mov_b32 s49, s48
    v_cndmask_b32 v28, 2.0, v28, s[48:49]
    v_mov_b32 v29, 0xff800000
    v_mov_b32 v15, 0x3f803f80
    s_mov_b32 s58, 0x00100000
    s_mov_b32 s59, s58
    v_mov_b64 v[96:97], 0
    v_mov_b64 v[98:99], 0
    v_mov_b64 v[100:101], 0
    v_mov_b64 v[102:103], 0
    v_mov_b64 v[104:105], 0
    v_mov_b64 v[106:107], 0
    v_mov_b64 v[108:109], 0
    v_mov_b64 v[110:111], 0
    v_mov_b64 v[112:113], 0
    v_mov_b64 v[114:115], 0
    v_mov_b64 v[116:117], 0
    v_mov_b64 v[118:119], 0
    v_mov_b64 v[120:121], 0
    v_mov_b64 v[122:123], 0
    v_mov_b64 v[124:125], 0
    v_mov_b64 v[126:127], 0
L_slow_pass:
    s_mov_b32 s62, 0
L_slow_loop:
    s_lshr_b32 s47, s62, 1
    s_mul_i32 s47, s47, 10240
    s_add_u32 s47, s47, s52
    s_and_b32 s48, s62, 1
    s_lshl_b32 s49, s48, 11
    s_add_u32 s49, s49, s47
    s_lshl_b32 s50, s48, 9
    s_add_u32 s50, s50, s47
    s_mul_i32 s51, s48, 2560
    s_add_u32 s51, s51, s47
    buffer_load_dwordx2 v[20:21], v151, s[24:27], s50 offen sc1
    buffer_load_dwordx4 v[16:19], v150, s[24:27], s49 offen sc1
    buffer_load_dwordx4 v[24:27], v150, s[24:27], s49 offen offset:1024 sc1
    buffer_load_dwordx4 v[64:67], v28, s[24:27], s51 offen offset:0 sc1
    buffer_load_dwordx4 v[68:71], v28, s[24:27], s51 offen offset:640 sc1
    buffer_load_dwordx4 v[72:75], v28, s[24:27], s51 offen offset:1280 sc1
    buffer_load_dwordx4 v[76:79], v28, s[24:27], s51 offen offset:1920 sc1
    s_waitcnt vmcnt(0)
    v_mfma_f32_32x32x4_2b_bf16 v[32:63], v[20:21], v[2:3], 0
    v_cndmask_b32 v64, v64, v15, s[58:59]
    v_cndmask_b32 v65, v65, v15, s[58:59]
    v_cndmask_b32 v66, v66, v15, s[58:59]
    v_cndmask_b32 v67, v67, v15, s[58:59]
    v_cndmask_b32 v68, v68, v15, s[58:59]
    v_cndmask_b32 v69, v69, v15, s[58:59]
    v_cndmask_b32 v70, v70, v15, s[58:59]
    v_cndmask_b32 v71, v71, v15, s[58:59]
    v_cndmask_b32 v72, v72, v15, s[58:59]
    v_cndmask_b32 v73, v73, v15, s[58:59]
    v_cndmask_b32 v74, v74, v15, s[58:59]
    v_cndmask_b32 v75, v75, v15, s[58:59]
    v_cndmask_b32 v76, v76, v15, s[58:59]
    v_cndmask_b32 v77, v77, v15, s[58:59]
    v_cndmask_b32 v78, v78, v15, s[58:59]
    v_cndmask_b32 v79, v79, v15, s[58:59]
    s_nop 3
    v_mfma_f32_32x32x16_bf16 v[32:47], v[16:19], v[4:7], v[32:47]
    v_mfma_f32_32x32x16_bf16 v[48:63], v[24:27], v[4:7], v[48:63]
    s_cmp_lg_u32 s56, 0
    s_nop 11
    s_cbranch_scc1 L_slow_2
    v_max3_f32 v29, v29, v32, v33
    v_max3_f32 v29, v29, v34, v35
    v_max3_f32 v29, v29, v36, v37
    v_max3_f32 v29, v29, v38, v39
    v_max3_f32 v29, v29, v40, v41
    v_max3_f32 v29, v29, v42, v43
    v_max3_f32 v29, v29, v44, v45
    v_max3_f32 v29, v29, v46, v47
    v_max3_f32 v29, v29, v48, v49
    v_max3_f32 v29, v29, v50, v51
    v_max3_f32 v29, v29, v52, v53
    v_max3_f32 v29, v29, v54, v55
    v_max3_f32 v29, v29, v56, v57
    v_max3_f32 v29, v29, v58, v59
    v_max3_f32 v29, v29, v60, v61
    v_max3_f32 v29, v29, v62, v63
    s_branch L_slow_next
L_slow_2:
    v_sub_f32 v32, v32, v29
    v_sub_f32 v33, v33, v29
    v_sub_f32 v34, v34, v29
    v_sub_f32 v35, v35, v29
    v_sub_f32 v36, v36, v29
    v_sub_f32 v37, v37, v29
    v_sub_f32 v38, v38, v29
    v_sub_f32 v39, v39, v29
    v_sub_f32 v40, v40, v29
    v_sub_f32 v41, v41, v29
    v_sub_f32 v42, v42, v29
    v_sub_f32 v43, v43, v29
    v_sub_f32 v44, v44, v29
    v_sub_f32 v45, v45, v29
    v_sub_f32 v46, v46, v29
    v_sub_f32 v47, v47, v29
    v_sub_f32 v48, v48, v29
    v_sub_f32 v49, v49, v29
    v_sub_f32 v50, v50, v29
    v_sub_f32 v51, v51, v29
    v_sub_f32 v52, v52, v29
    v_sub_f32 v53, v53, v29
    v_sub_f32 v54, v54, v29
    v_sub_f32 v55, v55, v29
    v_sub_f32 v56, v56, v29
    v_sub_f32 v57, v57, v29
    v_sub_f32 v58, v58, v29
    v_sub_f32 v59, v59, v29
    v_sub_f32 v60, v60, v29
    v_sub_f32 v61, v61, v29
    v_sub_f32 v62, v62, v29
    v_sub_f32 v63, v63, v29
    v_exp_f32 v32, v32
    v_exp_f32 v33, v33
    v_exp_f32 v34, v34
    v_exp_f32 v35, v35
    v_exp_f32 v36, v36
    v_exp_f32 v37, v37
    v_exp_f32 v38, v38
    v_exp_f32 v39, v39
    v_exp_f32 v40, v40
    v_exp_f32 v41, v41
    v_exp_f32 v42, v42
    v_exp_f32 v43, v43
    v_exp_f32 v44, v44
    v_exp_f32 v45, v45
    v_exp_f32 v46, v46
    v_exp_f32 v47, v47
    v_exp_f32 v48, v48
    v_exp_f32 v49, v49
    v_exp_f32 v50, v50
    v_exp_f32 v51, v51
    v_exp_f32 v52, v52
    v_exp_f32 v53, v53
    v_exp_f32 v54, v54
    v_exp_f32 v55, v55
    v_exp_f32 v56, v56
    v_exp_f32 v57, v57
    v_exp_f32 v58, v58
    v_exp_f32 v59, v59
    v_exp_f32 v60, v60
    v_exp_f32 v61, v61
    v_exp_f32 v62, v62
    v_exp_f32 v63, v63
    s_nop 1
    v_smfmac_f32_32x32x32_bf16 v[96:111], v[64:67], v[32:39], v14
    v_smfmac_f32_32x32x32_bf16 v[96:111], v[68:71], v[40:47], v14
    v_smfmac_f32_32x32x32_bf16 v[96:111], v[72:75], v[48:55], v14
    v_smfmac_f32_32x32x32_bf16 v[96:111], v[76:79], v[56:63], v14
L_slow_next:
    s_add_u32 s62, s62, 1
    s_cmp_lt_u32 s62, 32
    s_cbranch_scc1 L_slow_loop
    s_cmp_lg_u32 s56, 0
    s_nop 11
    s_cbranch_scc1 L_norm
    v_mov_b32 v30, v29
    s_mov_b32 s56, 1
    s_nop 0
    v_permlane32_swap_b32 v29, v30
    s_nop 1
    v_max_f32 v29, v29, v30
    s_branch L_slow_pass
L_service:
L_pad5:
    s_cbranch_execz L_pad6
    s_load_dwordx2 s[36:37], s[0:1], 32
    s_movk_i32 s38, 256
    s_mov_b32 s39, s27
    v_lshlrev_b32 v1, 4, v0
    v_mov_b32 v12, 1
    v_mov_b32 v11, 126976
    v_mov_b64 v[4:5], 0
    v_mov_b64 v[6:7], 0
    s_cmpk_ge_u32 s2, 240
    s_waitcnt lgkmcnt(0)
    s_cbranch_scc0 L_svc_tile
    s_sub_u32 s48, s2, 240
    s_mul_i32 s47, s48, 18432
    s_add_u32 s47, s47, 14057472
    buffer_store_dwordx4 v[4:7], v1, s[24:27], s47 offen offset:0 sc1
    buffer_store_dwordx4 v[4:7], v1, s[24:27], s47 offen offset:1024 sc1
    buffer_store_dwordx4 v[4:7], v1, s[24:27], s47 offen offset:2048 sc1
    buffer_store_dwordx4 v[4:7], v1, s[24:27], s47 offen offset:3072 sc1
    s_add_u32 s47, s47, 4096
    buffer_store_dwordx4 v[4:7], v1, s[24:27], s47 offen offset:0 sc1
    buffer_store_dwordx4 v[4:7], v1, s[24:27], s47 offen offset:1024 sc1
    buffer_store_dwordx4 v[4:7], v1, s[24:27], s47 offen offset:2048 sc1
    buffer_store_dwordx4 v[4:7], v1, s[24:27], s47 offen offset:3072 sc1
    s_add_u32 s47, s47, 4096
    buffer_store_dwordx4 v[4:7], v1, s[24:27], s47 offen offset:0 sc1
    buffer_store_dwordx4 v[4:7], v1, s[24:27], s47 offen offset:1024 sc1
    buffer_store_dwordx4 v[4:7], v1, s[24:27], s47 offen offset:2048 sc1
    buffer_store_dwordx4 v[4:7], v1, s[24:27], s47 offen offset:3072 sc1
    s_add_u32 s47, s47, 4096
    buffer_store_dwordx4 v[4:7], v1, s[24:27], s47 offen offset:0 sc1
    buffer_store_dwordx4 v[4:7], v1, s[24:27], s47 offen offset:1024 sc1
    buffer_store_dwordx4 v[4:7], v1, s[24:27], s47 offen offset:2048 sc1
    buffer_store_dwordx4 v[4:7], v1, s[24:27], s47 offen offset:3072 sc1
    s_add_u32 s47, s47, 4096
    buffer_store_dwordx4 v[4:7], v1, s[24:27], s47 offen offset:0 sc1
    buffer_store_dwordx4 v[4:7], v1, s[24:27], s47 offen offset:1024 sc1
    s_lshl_b32 s48, s48, 2
    s_mov_b64 exec, 1
    s_waitcnt vmcnt(0)
    buffer_store_dword v12, off, s[36:39], s48 sc1
    s_mov_b64 exec, -1
L_svc_tile:
    s_barrier
    v_and_b32 v13, 15, v0
    v_lshlrev_b32 v13, 2, v13
    s_and_b32 s43, s2, 7
    s_lshl_b32 s43, s43, 2
    s_lshr_b32 s43, 0x73625140, s43
    s_and_b32 s43, s43, 7
    s_bfe_u32 s44, s2, 0x20003
    s_lshl2_add_u32 s43, s43, s44
    s_lshr_b32 s44, s2, 5
    s_mul_i32 s52, s43, 163840
    s_mul_i32 s49, s42, 13
    s_lshr_b32 s49, s49, 6
    s_mul_i32 s50, s49, 5
    s_sub_u32 s50, s42, s50
    s_mul_i32 s47, s50, 205
    s_lshr_b32 s48, s47, 5
    s_add_u32 s47, s47, 203
    s_lshr_b32 s47, s47, 5
    v_lshrrev_b32 v2, 3, v0
    v_and_b32 v3, 7, v0
    v_add_u32 v8, s48, v2
    v_cmp_ge_u32 vcc, s47, v8
    v_and_b32 v9, 28, v8
    s_mov_b32 s47, 0x75316420
    v_bfe_u32 v9, s47, v9, 3
    v_and_b32 v8, 3, v8
    v_lshl_add_u32 v9, v8, 3, v9
    v_lshl_add_u32 v9, v3, 5, v9
    v_mul_u32_u24 v9, 640, v9
    s_cmp_lg_u32 s50, 0
    s_cselect_b64 s[50:51], 0xff, 0
    v_cndmask_b32 v8, 0, 1, s[50:51]
    v_add_u32 v9, v9, v8
    s_lshr_b32 s47, s41, 1
    s_lshl_b32 s50, 0x01010101, s47
    s_cmp_eq_u32 s49, 0
    s_cselect_b32 s50, s50, -1
    s_mov_b32 s51, s50
    s_and_b64 vcc, vcc, s[50:51]
    v_cndmask_b32 v5, 2.0, v9, vcc
    s_lshr_b32 s47, s41, 2
    s_lshl_b32 s47, s47, 5
    s_and_b32 s48, s41, 3
    s_add_u32 s47, s47, s48
    s_lshl2_add_u32 s47, s47, 128
    s_cmp_eq_u32 s41, 0
    s_cmov_b32 s47, 4
    s_lshl1_add_u32 s47, s49, s47
    s_sub_u32 s47, s47, 2
    s_and_b32 s48, s41, 1
    s_lshl_b32 s48, s48, 1
    s_cmp_eq_u32 s49, 0
    s_cselect_b32 s54, s48, s47
    s_cmpk_lt_u32 s2, 240
    s_cbranch_scc1 L_svc_b
    s_bfe_u32 s47, s2, 0x30001
    s_lshl_b32 s47, s47, 3
    v_lshl_add_u32 v9, v2, 6, v3
    v_add_u32 v9, s47, v9
    v_mul_u32_u24 v9, 640, v9
    s_mov_b32 s50, -1
    s_mov_b32 s51, 0
    v_cndmask_b32 v5, 2.0, v9, s[50:51]
    s_and_b32 s54, s2, 1
    s_add_u32 s54, s54, 8
    s_branch L_svc_a
L_svc_b:
    s_barrier
L_svc_a:
    s_add_u32 s54, s54, 14188544
    v_lshl_add_u32 v14, v0, 3, s44
    v_lshlrev_b32 v14, 9, v14
    s_mov_b32 s50, -1
    s_mov_b32 s51, 0
    v_cndmask_b32 v14, 2.0, v14, s[50:51]
    s_lshr_b32 s53, s43, 3
    s_lshl_b32 s53, s53, 5
    s_and_b32 s47, s43, 7
    s_add_u32 s53, s53, s47
    s_lshl2_add_u32 s53, s53, 14057472
    s_mul_i32 s47, s2, 640
    s_add_u32 s47, s47, 14188544
    s_add_u32 s12, s24, s47
    s_addc_u32 s13, s25, 0
    s_lshl_b32 s47, s2, 9
    s_add_u32 s47, s47, 14057472
    s_add_u32 s14, s24, s47
    s_addc_u32 s15, s25, 0
    s_mul_i32 s47, s43, 20
    s_add_u32 s48, s47, 19
    s_xor_b32 s47, s47, s48
    s_cmpk_lt_u32 s47, 128
    s_cselect_b32 s55, 0x01000100, 0
    v_mov_b64 v[16:17], -1
    v_mov_b64 v[18:19], -1
    v_lshlrev_b32 v15, 2, v0
    v_and_b32 v20, 28, v15
    v_add_u32 v20, 127232, v20
    s_bfe_u32 s46, s2, 0x30003
    s_mul_i32 s46, s46, 102400
    s_add_u32 s46, s46, 13107200
    s_mul_i32 s45, s44, 20480
    s_add_u32 s45, s45, s52
    s_add_u32 s45, s45, 5242880
    s_cmpk_ge_u32 s2, 240
    s_cbranch_scc1 L_svc_chk
    s_barrier
    s_barrier
    s_barrier
    s_barrier
    s_barrier
    s_barrier
    s_barrier
    s_barrier
L_svc_chk:
    s_mov_b32 s63, 131072
L_p7:
    buffer_load_dword v9, v13, s[36:39], 0 offen sc1
L_pc7:
    s_sub_u32 s63, s63, 1
    s_cbranch_scc1 L_pd7
    s_waitcnt vmcnt(0)
    v_cmp_eq_u32 vcc, 0, v9
    s_cbranch_vccnz L_p7
L_pd7:
    s_setprio 3
    s_barrier
    buffer_store_byte v12, v5, s[24:27], s54 offen sc1
    s_mov_b32 s63, 131072
L_p8:
    s_load_dwordx4 s[4:7], s[12:13], 0 glc
L_pc8:
    s_sub_u32 s63, s63, 1
    s_cbranch_scc1 L_pd8
    s_waitcnt lgkmcnt(0)
    s_or_b32 s4, s4, s55
    s_cmp_lg_u32 s4, 0x01010101
    s_cbranch_scc0 L_svc_q1
    s_or_b32 s5, s5, s55
    s_cmp_lg_u32 s5, 0x01010101
    s_cbranch_scc1 L_p8
L_pd8:
    s_load_dwordx4 s[4:7], s[12:13], 0 glc
    s_mov_b32 m0, 153344
    s_add_u32 s47, s52, 0
    buffer_load_dwordx4 v1, s[24:27], s47 offen offset:0 sc1 lds
    buffer_load_dwordx4 v1, s[24:27], s47 offen offset:1024 sc1 lds
    buffer_load_dwordx4 v1, s[24:27], s47 offen offset:2048 sc1 lds
    buffer_load_dwordx4 v1, s[24:27], s47 offen offset:3072 sc1 lds
    s_mov_b32 m0, 157440
    s_add_u32 s47, s52, 4096
    buffer_load_dwordx4 v1, s[24:27], s47 offen offset:0 sc1 lds
    buffer_load_dwordx4 v1, s[24:27], s47 offen offset:1024 sc1 lds
    buffer_load_dwordx4 v1, s[24:27], s47 offen offset:2048 sc1 lds
    buffer_load_dwordx4 v1, s[24:27], s47 offen offset:3072 sc1 lds
    s_mov_b32 m0, 161536
    s_add_u32 s47, s52, 8192
    buffer_load_dwordx4 v1, s[24:27], s47 offen offset:0 sc1 lds
    buffer_load_dwordx4 v1, s[24:27], s47 offen offset:1024 sc1 lds
    s_mov_b32 s63, 131072
    s_branch L_pc9
L_p9:
    s_load_dwordx4 s[4:7], s[12:13], 0 glc
L_pc9:
    s_sub_u32 s63, s63, 1
    s_cbranch_scc1 L_pd9
    s_waitcnt lgkmcnt(0)
    s_or_b32 s4, s4, s55
    s_cmp_lg_u32 s4, 0x01010101
    s_cbranch_scc1 L_p9
L_pd9:
    s_mov_b32 m0, 142848
    s_add_u32 s47, s45, 0
    buffer_load_dwordx4 v1, s[24:27], s47 offen offset:0 sc1 lds
    buffer_load_dwordx4 v1, s[24:27], s47 offen offset:1024 sc1 lds
    buffer_load_dwordx4 v1, s[24:27], s47 offen offset:2048 sc1 lds
    buffer_load_dwordx4 v1, s[24:27], s47 offen offset:3072 sc1 lds
    s_mov_b32 m0, 146944
    s_add_u32 s47, s45, 4096
    buffer_load_dwordx4 v1, s[24:27], s47 offen offset:0 sc1 lds
    s_mov_b32 m0, 147968
    s_add_u32 s47, s45, 10240
    buffer_load_dwordx4 v1, s[24:27], s47 offen offset:0 sc1 lds
    buffer_load_dwordx4 v1, s[24:27], s47 offen offset:1024 sc1 lds
    buffer_load_dwordx4 v1, s[24:27], s47 offen offset:2048 sc1 lds
    buffer_load_dwordx4 v1, s[24:27], s47 offen offset:3072 sc1 lds
    s_mov_b32 m0, 152064
    s_add_u32 s47, s45, 14336
    buffer_load_dwordx4 v1, s[24:27], s47 offen offset:0 sc1 lds
    s_branch L_svc_q
L_svc_q1:
    s_mov_b32 m0, 142848
    s_add_u32 s47, s45, 0
    buffer_load_dwordx4 v1, s[24:27], s47 offen offset:0 sc1 lds
    buffer_load_dwordx4 v1, s[24:27], s47 offen offset:1024 sc1 lds
    buffer_load_dwordx4 v1, s[24:27], s47 offen offset:2048 sc1 lds
    buffer_load_dwordx4 v1, s[24:27], s47 offen offset:3072 sc1 lds
    s_mov_b32 m0, 146944
    s_add_u32 s47, s45, 4096
    buffer_load_dwordx4 v1, s[24:27], s47 offen offset:0 sc1 lds
    s_mov_b32 m0, 147968
    s_add_u32 s47, s45, 10240
    buffer_load_dwordx4 v1, s[24:27], s47 offen offset:0 sc1 lds
    buffer_load_dwordx4 v1, s[24:27], s47 offen offset:1024 sc1 lds
    buffer_load_dwordx4 v1, s[24:27], s47 offen offset:2048 sc1 lds
    buffer_load_dwordx4 v1, s[24:27], s47 offen offset:3072 sc1 lds
    s_mov_b32 m0, 152064
    s_add_u32 s47, s45, 14336
    buffer_load_dwordx4 v1, s[24:27], s47 offen offset:0 sc1 lds
    s_mov_b32 s63, 131072
    s_branch L_pc10
L_p10:
    s_load_dwordx4 s[4:7], s[12:13], 0 glc
L_pc10:
    s_sub_u32 s63, s63, 1
    s_cbranch_scc1 L_pd10
    s_waitcnt lgkmcnt(0)
    s_or_b32 s5, s5, s55
    s_cmp_lg_u32 s5, 0x01010101
    s_cbranch_scc1 L_p10
L_pd10:
    s_mov_b32 m0, 153344
    s_add_u32 s47, s52, 0
    buffer_load_dwordx4 v1, s[24:27], s47 offen offset:0 sc1 lds
    buffer_load_dwordx4 v1, s[24:27], s47 offen offset:1024 sc1 lds
    buffer_load_dwordx4 v1, s[24:27], s47 offen offset:2048 sc1 lds
    buffer_load_dwordx4 v1, s[24:27], s47 offen offset:3072 sc1 lds
    s_mov_b32 m0, 157440
    s_add_u32 s47, s52, 4096
    buffer_load_dwordx4 v1, s[24:27], s47 offen offset:0 sc1 lds
    buffer_load_dwordx4 v1, s[24:27], s47 offen offset:1024 sc1 lds
    buffer_load_dwordx4 v1, s[24:27], s47 offen offset:2048 sc1 lds
    buffer_load_dwordx4 v1, s[24:27], s47 offen offset:3072 sc1 lds
    s_mov_b32 m0, 161536
    s_add_u32 s47, s52, 8192
    buffer_load_dwordx4 v1, s[24:27], s47 offen offset:0 sc1 lds
    buffer_load_dwordx4 v1, s[24:27], s47 offen offset:1024 sc1 lds
L_svc_q:
    s_load_dwordx4 s[4:7], s[12:13], 128 glc
    s_load_dwordx4 s[8:11], s[12:13], 256 glc
    s_load_dwordx4 s[16:19], s[12:13], 384 glc
    s_load_dwordx4 s[20:23], s[12:13], 512 glc
    s_waitcnt vmcnt(0)
    s_barrier
    s_mov_b32 s63, 131072
    s_branch L_pc11
L_p11:
    s_load_dwordx4 s[4:7], s[12:13], 128 glc
    s_load_dwordx4 s[8:11], s[12:13], 256 glc
    s_load_dwordx4 s[16:19], s[12:13], 384 glc
    s_load_dwordx4 s[20:23], s[12:13], 512 glc
L_pc11:
    s_sub_u32 s63, s63, 1
    s_cbranch_scc1 L_pd11
    s_waitcnt lgkmcnt(0)
    s_and_b64 s[8:9], s[8:9], s[6:7]
    s_and_b64 s[10:11], s[10:11], s[16:17]
    s_and_b64 s[18:19], s[18:19], s[20:21]
    s_and_b64 s[8:9], s[8:9], s[22:23]
    s_and_b64 s[10:11], s[10:11], s[18:19]
    s_and_b64 s[8:9], s[8:9], s[10:11]
    s_and_b32 s8, s8, s9
    s_and_b32 s8, s8, s5
    s_or_b32 s8, s8, s55
    s_cmp_lg_u32 s8, 0x01010101
    s_cbranch_scc1 L_p11
L_pd11:
    s_mov_b32 m0, 6400
    s_add_u32 s47, s52, 10240
    buffer_load_dwordx4 v1, s[24:27], s47 offen offset:0 sc1 lds
    buffer_load_dwordx4 v1, s[24:27], s47 offen offset:1024 sc1 lds
    buffer_load_dwordx4 v1, s[24:27], s47 offen offset:2048 sc1 lds
    buffer_load_dwordx4 v1, s[24:27], s47 offen offset:3072 sc1 lds
    s_mov_b32 m0, 10496
    s_add_u32 s47, s52, 14336
    buffer_load_dwordx4 v1, s[24:27], s47 offen offset:0 sc1 lds
    buffer_load_dwordx4 v1, s[24:27], s47 offen offset:1024 sc1 lds
    buffer_load_dwordx4 v1, s[24:27], s47 offen offset:2048 sc1 lds
    buffer_load_dwordx4 v1, s[24:27], s47 offen offset:3072 sc1 lds
    s_mov_b32 m0, 14592
    s_add_u32 s47, s52, 18432
    buffer_load_dwordx4 v1, s[24:27], s47 offen offset:0 sc1 lds
    buffer_load_dwordx4 v1, s[24:27], s47 offen offset:1024 sc1 lds
    s_mov_b32 m0, 16896
    s_add_u32 s47, s52, 20480
    buffer_load_dwordx4 v1, s[24:27], s47 offen offset:0 sc1 lds
    buffer_load_dwordx4 v1, s[24:27], s47 offen offset:1024 sc1 lds
    buffer_load_dwordx4 v1, s[24:27], s47 offen offset:2048 sc1 lds
    buffer_load_dwordx4 v1, s[24:27], s47 offen offset:3072 sc1 lds
    s_mov_b32 m0, 20992
    s_add_u32 s47, s52, 24576
    buffer_load_dwordx4 v1, s[24:27], s47 offen offset:0 sc1 lds
    buffer_load_dwordx4 v1, s[24:27], s47 offen offset:1024 sc1 lds
    buffer_load_dwordx4 v1, s[24:27], s47 offen offset:2048 sc1 lds
    buffer_load_dwordx4 v1, s[24:27], s47 offen offset:3072 sc1 lds
    s_mov_b32 m0, 25088
    s_add_u32 s47, s52, 28672
    buffer_load_dwordx4 v1, s[24:27], s47 offen offset:0 sc1 lds
    buffer_load_dwordx4 v1, s[24:27], s47 offen offset:1024 sc1 lds
    s_mov_b32 m0, 27392
    s_add_u32 s47, s52, 30720
    buffer_load_dwordx4 v1, s[24:27], s47 offen offset:0 sc1 lds
    buffer_load_dwordx4 v1, s[24:27], s47 offen offset:1024 sc1 lds
    buffer_load_dwordx4 v1, s[24:27], s47 offen offset:2048 sc1 lds
    buffer_load_dwordx4 v1, s[24:27], s47 offen offset:3072 sc1 lds
    s_mov_b32 m0, 31488
    s_add_u32 s47, s52, 34816
    buffer_load_dwordx4 v1, s[24:27], s47 offen offset:0 sc1 lds
    buffer_load_dwordx4 v1, s[24:27], s47 offen offset:1024 sc1 lds
    buffer_load_dwordx4 v1, s[24:27], s47 offen offset:2048 sc1 lds
    buffer_load_dwordx4 v1, s[24:27], s47 offen offset:3072 sc1 lds
    s_mov_b32 m0, 35584
    s_add_u32 s47, s52, 38912
    buffer_load_dwordx4 v1, s[24:27], s47 offen offset:0 sc1 lds
    buffer_load_dwordx4 v1, s[24:27], s47 offen offset:1024 sc1 lds
    s_waitcnt vmcnt(20)
    s_barrier
    s_mov_b32 m0, 37888
    s_add_u32 s47, s52, 40960
    buffer_load_dwordx4 v1, s[24:27], s47 offen offset:0 sc1 lds
    buffer_load_dwordx4 v1, s[24:27], s47 offen offset:1024 sc1 lds
    buffer_load_dwordx4 v1, s[24:27], s47 offen offset:2048 sc1 lds
    buffer_load_dwordx4 v1, s[24:27], s47 offen offset:3072 sc1 lds
    s_mov_b32 m0, 41984
    s_add_u32 s47, s52, 45056
    buffer_load_dwordx4 v1, s[24:27], s47 offen offset:0 sc1 lds
    buffer_load_dwordx4 v1, s[24:27], s47 offen offset:1024 sc1 lds
    buffer_load_dwordx4 v1, s[24:27], s47 offen offset:2048 sc1 lds
    buffer_load_dwordx4 v1, s[24:27], s47 offen offset:3072 sc1 lds
    s_mov_b32 m0, 46080
    s_add_u32 s47, s52, 49152
    buffer_load_dwordx4 v1, s[24:27], s47 offen offset:0 sc1 lds
    buffer_load_dwordx4 v1, s[24:27], s47 offen offset:1024 sc1 lds
    s_mov_b32 m0, 48384
    s_add_u32 s47, s52, 51200
    buffer_load_dwordx4 v1, s[24:27], s47 offen offset:0 sc1 lds
    buffer_load_dwordx4 v1, s[24:27], s47 offen offset:1024 sc1 lds
    buffer_load_dwordx4 v1, s[24:27], s47 offen offset:2048 sc1 lds
    buffer_load_dwordx4 v1, s[24:27], s47 offen offset:3072 sc1 lds
    s_mov_b32 m0, 52480
    s_add_u32 s47, s52, 55296
    buffer_load_dwordx4 v1, s[24:27], s47 offen offset:0 sc1 lds
    buffer_load_dwordx4 v1, s[24:27], s47 offen offset:1024 sc1 lds
    buffer_load_dwordx4 v1, s[24:27], s47 offen offset:2048 sc1 lds
    buffer_load_dwordx4 v1, s[24:27], s47 offen offset:3072 sc1 lds
    s_mov_b32 m0, 56576
    s_add_u32 s47, s52, 59392
    buffer_load_dwordx4 v1, s[24:27], s47 offen offset:0 sc1 lds
    buffer_load_dwordx4 v1, s[24:27], s47 offen offset:1024 sc1 lds
    s_waitcnt vmcnt(20)
    s_barrier
    s_mov_b32 m0, 58880
    s_add_u32 s47, s52, 61440
    buffer_load_dwordx4 v1, s[24:27], s47 offen offset:0 sc1 lds
    buffer_load_dwordx4 v1, s[24:27], s47 offen offset:1024 sc1 lds
    buffer_load_dwordx4 v1, s[24:27], s47 offen offset:2048 sc1 lds
    buffer_load_dwordx4 v1, s[24:27], s47 offen offset:3072 sc1 lds
    s_mov_b32 m0, 62976
    s_add_u32 s47, s52, 65536
    buffer_load_dwordx4 v1, s[24:27], s47 offen offset:0 sc1 lds
    buffer_load_dwordx4 v1, s[24:27], s47 offen offset:1024 sc1 lds
    buffer_load_dwordx4 v1, s[24:27], s47 offen offset:2048 sc1 lds
    buffer_load_dwordx4 v1, s[24:27], s47 offen offset:3072 sc1 lds
    s_mov_b32 m0, 67072
    s_add_u32 s47, s52, 69632
    buffer_load_dwordx4 v1, s[24:27], s47 offen offset:0 sc1 lds
    buffer_load_dwordx4 v1, s[24:27], s47 offen offset:1024 sc1 lds
    s_mov_b32 m0, 69376
    s_add_u32 s47, s52, 71680
    buffer_load_dwordx4 v1, s[24:27], s47 offen offset:0 sc1 lds
    buffer_load_dwordx4 v1, s[24:27], s47 offen offset:1024 sc1 lds
    buffer_load_dwordx4 v1, s[24:27], s47 offen offset:2048 sc1 lds
    buffer_load_dwordx4 v1, s[24:27], s47 offen offset:3072 sc1 lds
    s_mov_b32 m0, 73472
    s_add_u32 s47, s52, 75776
    buffer_load_dwordx4 v1, s[24:27], s47 offen offset:0 sc1 lds
    buffer_load_dwordx4 v1, s[24:27], s47 offen offset:1024 sc1 lds
    buffer_load_dwordx4 v1, s[24:27], s47 offen offset:2048 sc1 lds
    buffer_load_dwordx4 v1, s[24:27], s47 offen offset:3072 sc1 lds
    s_mov_b32 m0, 77568
    s_add_u32 s47, s52, 79872
    buffer_load_dwordx4 v1, s[24:27], s47 offen offset:0 sc1 lds
    buffer_load_dwordx4 v1, s[24:27], s47 offen offset:1024 sc1 lds
    s_mov_b32 m0, 79872
    s_add_u32 s47, s52, 81920
    buffer_load_dwordx4 v1, s[24:27], s47 offen offset:0 sc1 lds
    buffer_load_dwordx4 v1, s[24:27], s47 offen offset:1024 sc1 lds
    buffer_load_dwordx4 v1, s[24:27], s47 offen offset:2048 sc1 lds
    buffer_load_dwordx4 v1, s[24:27], s47 offen offset:3072 sc1 lds
    s_mov_b32 m0, 83968
    s_add_u32 s47, s52, 86016
    buffer_load_dwordx4 v1, s[24:27], s47 offen offset:0 sc1 lds
    buffer_load_dwordx4 v1, s[24:27], s47 offen offset:1024 sc1 lds
    buffer_load_dwordx4 v1, s[24:27], s47 offen offset:2048 sc1 lds
    buffer_load_dwordx4 v1, s[24:27], s47 offen offset:3072 sc1 lds
    s_mov_b32 m0, 88064
    s_add_u32 s47, s52, 90112
    buffer_load_dwordx4 v1, s[24:27], s47 offen offset:0 sc1 lds
    buffer_load_dwordx4 v1, s[24:27], s47 offen offset:1024 sc1 lds
    s_mov_b32 m0, 90368
    s_add_u32 s47, s52, 92160
    buffer_load_dwordx4 v1, s[24:27], s47 offen offset:0 sc1 lds
    buffer_load_dwordx4 v1, s[24:27], s47 offen offset:1024 sc1 lds
    buffer_load_dwordx4 v1, s[24:27], s47 offen offset:2048 sc1 lds
    buffer_load_dwordx4 v1, s[24:27], s47 offen offset:3072 sc1 lds
    s_mov_b32 m0, 94464
    s_add_u32 s47, s52, 96256
    buffer_load_dwordx4 v1, s[24:27], s47 offen offset:0 sc1 lds
    buffer_load_dwordx4 v1, s[24:27], s47 offen offset:1024 sc1 lds
    buffer_load_dwordx4 v1, s[24:27], s47 offen offset:2048 sc1 lds
    buffer_load_dwordx4 v1, s[24:27], s47 offen offset:3072 sc1 lds
    s_mov_b32 m0, 98560
    s_add_u32 s47, s52, 100352
    buffer_load_dwordx4 v1, s[24:27], s47 offen offset:0 sc1 lds
    buffer_load_dwordx4 v1, s[24:27], s47 offen offset:1024 sc1 lds
    s_waitcnt vmcnt(20)
    s_barrier
    s_mov_b32 m0, 100864
    s_add_u32 s47, s52, 102400
    buffer_load_dwordx4 v1, s[24:27], s47 offen offset:0 sc1 lds
    buffer_load_dwordx4 v1, s[24:27], s47 offen offset:1024 sc1 lds
    buffer_load_dwordx4 v1, s[24:27], s47 offen offset:2048 sc1 lds
    buffer_load_dwordx4 v1, s[24:27], s47 offen offset:3072 sc1 lds
    s_mov_b32 m0, 104960
    s_add_u32 s47, s52, 106496
    buffer_load_dwordx4 v1, s[24:27], s47 offen offset:0 sc1 lds
    buffer_load_dwordx4 v1, s[24:27], s47 offen offset:1024 sc1 lds
    buffer_load_dwordx4 v1, s[24:27], s47 offen offset:2048 sc1 lds
    buffer_load_dwordx4 v1, s[24:27], s47 offen offset:3072 sc1 lds
    s_mov_b32 m0, 109056
    s_add_u32 s47, s52, 110592
    buffer_load_dwordx4 v1, s[24:27], s47 offen offset:0 sc1 lds
    buffer_load_dwordx4 v1, s[24:27], s47 offen offset:1024 sc1 lds
    s_mov_b32 m0, 111360
    s_add_u32 s47, s52, 112640
    buffer_load_dwordx4 v1, s[24:27], s47 offen offset:0 sc1 lds
    buffer_load_dwordx4 v1, s[24:27], s47 offen offset:1024 sc1 lds
    buffer_load_dwordx4 v1, s[24:27], s47 offen offset:2048 sc1 lds
    buffer_load_dwordx4 v1, s[24:27], s47 offen offset:3072 sc1 lds
    s_mov_b32 m0, 115456
    s_add_u32 s47, s52, 116736
    buffer_load_dwordx4 v1, s[24:27], s47 offen offset:0 sc1 lds
    buffer_load_dwordx4 v1, s[24:27], s47 offen offset:1024 sc1 lds
    buffer_load_dwordx4 v1, s[24:27], s47 offen offset:2048 sc1 lds
    buffer_load_dwordx4 v1, s[24:27], s47 offen offset:3072 sc1 lds
    s_mov_b32 m0, 119552
    s_add_u32 s47, s52, 120832
    buffer_load_dwordx4 v1, s[24:27], s47 offen offset:0 sc1 lds
L_pad6:
    s_cbranch_execz L_padret
    buffer_load_dwordx4 v1, s[24:27], s47 offen offset:1024 sc1 lds
    s_mov_b32 m0, 121856
    s_add_u32 s47, s52, 122880
    buffer_load_dwordx4 v1, s[24:27], s47 offen offset:0 sc1 lds
    buffer_load_dwordx4 v1, s[24:27], s47 offen offset:1024 sc1 lds
    buffer_load_dwordx4 v1, s[24:27], s47 offen offset:2048 sc1 lds
    buffer_load_dwordx4 v1, s[24:27], s47 offen offset:3072 sc1 lds
    s_mov_b32 m0, 125952
    s_add_u32 s47, s52, 126976
    buffer_load_dwordx4 v1, s[24:27], s47 offen offset:0 sc1 lds
    buffer_load_dwordx4 v1, s[24:27], s47 offen offset:1024 sc1 lds
    buffer_load_dwordx4 v1, s[24:27], s47 offen offset:2048 sc1 lds
    buffer_load_dwordx4 v1, s[24:27], s47 offen offset:3072 sc1 lds
    s_mov_b32 m0, 130048
    s_add_u32 s47, s52, 131072
    buffer_load_dwordx4 v1, s[24:27], s47 offen offset:0 sc1 lds
    buffer_load_dwordx4 v1, s[24:27], s47 offen offset:1024 sc1 lds
    s_mov_b32 m0, 132352
    s_add_u32 s47, s52, 133120
    buffer_load_dwordx4 v1, s[24:27], s47 offen offset:0 sc1 lds
    buffer_load_dwordx4 v1, s[24:27], s47 offen offset:1024 sc1 lds
    buffer_load_dwordx4 v1, s[24:27], s47 offen offset:2048 sc1 lds
    buffer_load_dwordx4 v1, s[24:27], s47 offen offset:3072 sc1 lds
    s_mov_b32 m0, 136448
    s_add_u32 s47, s52, 137216
    buffer_load_dwordx4 v1, s[24:27], s47 offen offset:0 sc1 lds
    buffer_load_dwordx4 v1, s[24:27], s47 offen offset:1024 sc1 lds
    buffer_load_dwordx4 v1, s[24:27], s47 offen offset:2048 sc1 lds
    buffer_load_dwordx4 v1, s[24:27], s47 offen offset:3072 sc1 lds
    s_mov_b32 m0, 140544
    s_add_u32 s47, s52, 141312
    buffer_load_dwordx4 v1, s[24:27], s47 offen offset:0 sc1 lds
    buffer_load_dwordx4 v1, s[24:27], s47 offen offset:1024 sc1 lds
    s_waitcnt vmcnt(50)
    s_mov_b32 m0, 142848
    s_add_u32 s47, s52, 143360
    buffer_load_dwordx4 v1, s[24:27], s47 offen offset:0 sc1 lds
    buffer_load_dwordx4 v1, s[24:27], s47 offen offset:1024 sc1 lds
    buffer_load_dwordx4 v1, s[24:27], s47 offen offset:2048 sc1 lds
    buffer_load_dwordx4 v1, s[24:27], s47 offen offset:3072 sc1 lds
    s_mov_b32 m0, 146944
    s_add_u32 s47, s52, 147456
    buffer_load_dwordx4 v1, s[24:27], s47 offen offset:0 sc1 lds
    buffer_load_dwordx4 v1, s[24:27], s47 offen offset:1024 sc1 lds
    buffer_load_dwordx4 v1, s[24:27], s47 offen offset:2048 sc1 lds
    buffer_load_dwordx4 v1, s[24:27], s47 offen offset:3072 sc1 lds
    s_mov_b32 m0, 151040
    s_add_u32 s47, s52, 151552
    buffer_load_dwordx4 v1, s[24:27], s47 offen offset:0 sc1 lds
    buffer_load_dwordx4 v1, s[24:27], s47 offen offset:1024 sc1 lds
    s_waitcnt vmcnt(50)
    s_mov_b32 m0, 153344
    s_add_u32 s47, s52, 153600
    buffer_load_dwordx4 v1, s[24:27], s47 offen offset:0 sc1 lds
    buffer_load_dwordx4 v1, s[24:27], s47 offen offset:1024 sc1 lds
    buffer_load_dwordx4 v1, s[24:27], s47 offen offset:2048 sc1 lds
    buffer_load_dwordx4 v1, s[24:27], s47 offen offset:3072 sc1 lds
    s_mov_b32 m0, 157440
    s_add_u32 s47, s52, 157696
    buffer_load_dwordx4 v1, s[24:27], s47 offen offset:0 sc1 lds
    buffer_load_dwordx4 v1, s[24:27], s47 offen offset:1024 sc1 lds
    buffer_load_dwordx4 v1, s[24:27], s47 offen offset:2048 sc1 lds
    buffer_load_dwordx4 v1, s[24:27], s47 offen offset:3072 sc1 lds
    s_mov_b32 m0, 161536
    s_add_u32 s47, s52, 161792
    buffer_load_dwordx4 v1, s[24:27], s47 offen offset:0 sc1 lds
    buffer_load_dwordx4 v1, s[24:27], s47 offen offset:1024 sc1 lds
    s_waitcnt vmcnt(20)
    s_barrier
    s_mul_i32 s47, s44, 327680
    s_lshr_b32 s48, s43, 3
    s_mul_i32 s48, s48, 10240
    s_add_u32 s47, s47, s48
    s_add_u32 s47, s47, 10485760
    s_and_b32 s49, s43, 7
    s_lshl_b32 s48, s49, 8
    s_add_u32 s48, s48, s47
    s_add_u32 s48, s48, 8192
    s_lshl_b32 s49, s49, 10
    s_add_u32 s47, s47, s49
    buffer_store_dwordx4 v[16:19], v1, s[24:27], s47 offen sc1
    buffer_store_dword v16, v15, s[24:27], s48 offen sc1
    s_add_u32 s47, s47, 40960
    s_add_u32 s48, s48, 40960
    buffer_store_dwordx4 v[16:19], v1, s[24:27], s47 offen sc1
    buffer_store_dword v16, v15, s[24:27], s48 offen sc1
    s_add_u32 s47, s47, 40960
    s_add_u32 s48, s48, 40960
    buffer_store_dwordx4 v[16:19], v1, s[24:27], s47 offen sc1
    buffer_store_dword v16, v15, s[24:27], s48 offen sc1
    s_add_u32 s47, s47, 40960
    s_add_u32 s48, s48, 40960
    buffer_store_dwordx4 v[16:19], v1, s[24:27], s47 offen sc1
    buffer_store_dword v16, v15, s[24:27], s48 offen sc1
    s_add_u32 s47, s47, 40960
    s_add_u32 s48, s48, 40960
    buffer_store_dwordx4 v[16:19], v1, s[24:27], s47 offen sc1
    buffer_store_dword v16, v15, s[24:27], s48 offen sc1
    s_add_u32 s47, s47, 40960
    s_add_u32 s48, s48, 40960
    buffer_store_dwordx4 v[16:19], v1, s[24:27], s47 offen sc1
    buffer_store_dword v16, v15, s[24:27], s48 offen sc1
    s_add_u32 s47, s47, 40960
    s_add_u32 s48, s48, 40960
    buffer_store_dwordx4 v[16:19], v1, s[24:27], s47 offen sc1
    buffer_store_dword v16, v15, s[24:27], s48 offen sc1
    s_add_u32 s47, s47, 40960
    s_add_u32 s48, s48, 40960
    buffer_store_dwordx4 v[16:19], v1, s[24:27], s47 offen sc1
    buffer_store_dword v16, v15, s[24:27], s48 offen sc1
    s_mov_b32 s63, 131072
L_p12:
    s_load_dwordx4 s[4:7], s[12:13], 0 glc
L_pc12:
    s_sub_u32 s63, s63, 1
    s_cbranch_scc1 L_pd12
    s_waitcnt lgkmcnt(0)
    s_cmpk_lg_u32 s6, 0x101
    s_cbranch_scc1 L_p12
L_pd12:
    s_waitcnt vmcnt(0)
    buffer_store_dword v12, v14, s[24:27], s53 offen offset:32 sc1
    s_mov_b32 m0, 0
    s_add_u32 s47, s46, 0
    buffer_load_dwordx4 v1, s[24:27], s47 offen offset:0 sc1 lds
    buffer_load_dwordx4 v1, s[24:27], s47 offen offset:1024 sc1 lds
    buffer_load_dwordx4 v1, s[24:27], s47 offen offset:2048 sc1 lds
    buffer_load_dwordx4 v1, s[24:27], s47 offen offset:3072 sc1 lds
    s_mov_b32 m0, 4096
    s_add_u32 s47, s46, 4096
    buffer_load_dwordx4 v1, s[24:27], s47 offen offset:0 sc1 lds
    buffer_load_dwordx4 v1, s[24:27], s47 offen offset:1024 sc1 lds
    buffer_load_dwordx4 v1, s[24:27], s47 offen offset:2048 sc1 lds
    buffer_load_dwordx4 v1, s[24:27], s47 offen offset:3072 sc1 lds
    s_mov_b32 m0, 8192
    s_add_u32 s47, s46, 8192
    buffer_load_dwordx4 v1, s[24:27], s47 offen offset:0 sc1 lds
    buffer_load_dwordx4 v1, s[24:27], s47 offen offset:1024 sc1 lds
    buffer_load_dwordx4 v1, s[24:27], s47 offen offset:2048 sc1 lds
    buffer_load_dwordx4 v1, s[24:27], s47 offen offset:3072 sc1 lds
    s_mov_b32 m0, 12288
    s_add_u32 s47, s46, 12288
    buffer_load_dwordx4 v1, s[24:27], s47 offen offset:0 sc1 lds
    buffer_load_dwordx4 v1, s[24:27], s47 offen offset:1024 sc1 lds
    buffer_load_dwordx4 v1, s[24:27], s47 offen offset:2048 sc1 lds
    buffer_load_dwordx4 v1, s[24:27], s47 offen offset:3072 sc1 lds
    s_mov_b32 m0, 16384
    s_add_u32 s47, s46, 16384
    buffer_load_dwordx4 v1, s[24:27], s47 offen offset:0 sc1 lds
    buffer_load_dwordx4 v1, s[24:27], s47 offen offset:1024 sc1 lds
    buffer_load_dwordx4 v1, s[24:27], s47 offen offset:2048 sc1 lds
    buffer_load_dwordx4 v1, s[24:27], s47 offen offset:3072 sc1 lds
    s_mov_b32 m0, 20480
    s_add_u32 s47, s46, 20480
    buffer_load_dwordx4 v1, s[24:27], s47 offen offset:0 sc1 lds
    buffer_load_dwordx4 v1, s[24:27], s47 offen offset:1024 sc1 lds
    buffer_load_dwordx4 v1, s[24:27], s47 offen offset:2048 sc1 lds
    buffer_load_dwordx4 v1, s[24:27], s47 offen offset:3072 sc1 lds
    s_mov_b32 m0, 24576
    s_add_u32 s47, s46, 24576
    buffer_load_dwordx4 v1, s[24:27], s47 offen offset:0 sc1 lds
    buffer_load_dwordx4 v1, s[24:27], s47 offen offset:1024 sc1 lds
    buffer_load_dwordx4 v1, s[24:27], s47 offen offset:2048 sc1 lds
    buffer_load_dwordx4 v1, s[24:27], s47 offen offset:3072 sc1 lds
    s_mov_b32 m0, 28672
    s_add_u32 s47, s46, 28672
    buffer_load_dwordx4 v1, s[24:27], s47 offen offset:0 sc1 lds
    buffer_load_dwordx4 v1, s[24:27], s47 offen offset:1024 sc1 lds
    buffer_load_dwordx4 v1, s[24:27], s47 offen offset:2048 sc1 lds
    buffer_load_dwordx4 v1, s[24:27], s47 offen offset:3072 sc1 lds
    s_mov_b32 m0, 32768
    s_add_u32 s47, s46, 32768
    buffer_load_dwordx4 v1, s[24:27], s47 offen offset:0 sc1 lds
    buffer_load_dwordx4 v1, s[24:27], s47 offen offset:1024 sc1 lds
    buffer_load_dwordx4 v1, s[24:27], s47 offen offset:2048 sc1 lds
    buffer_load_dwordx4 v1, s[24:27], s47 offen offset:3072 sc1 lds
    s_mov_b32 m0, 36864
    s_add_u32 s47, s46, 36864
    buffer_load_dwordx4 v1, s[24:27], s47 offen offset:0 sc1 lds
    buffer_load_dwordx4 v1, s[24:27], s47 offen offset:1024 sc1 lds
    buffer_load_dwordx4 v1, s[24:27], s47 offen offset:2048 sc1 lds
    buffer_load_dwordx4 v1, s[24:27], s47 offen offset:3072 sc1 lds
    s_waitcnt vmcnt(40)
    s_mov_b32 m0, 40960
    s_add_u32 s47, s46, 40960
    buffer_load_dwordx4 v1, s[24:27], s47 offen offset:0 sc1 lds
    buffer_load_dwordx4 v1, s[24:27], s47 offen offset:1024 sc1 lds
    buffer_load_dwordx4 v1, s[24:27], s47 offen offset:2048 sc1 lds
    buffer_load_dwordx4 v1, s[24:27], s47 offen offset:3072 sc1 lds
    s_waitcnt vmcnt(40)
    s_mov_b32 m0, 45056
    s_add_u32 s47, s46, 45056
    buffer_load_dwordx4 v1, s[24:27], s47 offen offset:0 sc1 lds
    buffer_load_dwordx4 v1, s[24:27], s47 offen offset:1024 sc1 lds
    buffer_load_dwordx4 v1, s[24:27], s47 offen offset:2048 sc1 lds
    buffer_load_dwordx4 v1, s[24:27], s47 offen offset:3072 sc1 lds
    s_waitcnt vmcnt(40)
    s_mov_b32 m0, 49152
    s_add_u32 s47, s46, 49152
    buffer_load_dwordx4 v1, s[24:27], s47 offen offset:0 sc1 lds
    buffer_load_dwordx4 v1, s[24:27], s47 offen offset:1024 sc1 lds
    buffer_load_dwordx4 v1, s[24:27], s47 offen offset:2048 sc1 lds
    buffer_load_dwordx4 v1, s[24:27], s47 offen offset:3072 sc1 lds
    s_waitcnt vmcnt(40)
    s_mov_b32 m0, 53248
    s_add_u32 s47, s46, 53248
    buffer_load_dwordx4 v1, s[24:27], s47 offen offset:0 sc1 lds
    buffer_load_dwordx4 v1, s[24:27], s47 offen offset:1024 sc1 lds
    buffer_load_dwordx4 v1, s[24:27], s47 offen offset:2048 sc1 lds
    buffer_load_dwordx4 v1, s[24:27], s47 offen offset:3072 sc1 lds
    s_waitcnt vmcnt(40)
    s_mov_b32 m0, 57344
    s_add_u32 s47, s46, 57344
    buffer_load_dwordx4 v1, s[24:27], s47 offen offset:0 sc1 lds
    buffer_load_dwordx4 v1, s[24:27], s47 offen offset:1024 sc1 lds
    buffer_load_dwordx4 v1, s[24:27], s47 offen offset:2048 sc1 lds
    buffer_load_dwordx4 v1, s[24:27], s47 offen offset:3072 sc1 lds
    s_waitcnt vmcnt(40)
    s_mov_b32 m0, 61440
    s_add_u32 s47, s46, 61440
    buffer_load_dwordx4 v1, s[24:27], s47 offen offset:0 sc1 lds
    buffer_load_dwordx4 v1, s[24:27], s47 offen offset:1024 sc1 lds
    buffer_load_dwordx4 v1, s[24:27], s47 offen offset:2048 sc1 lds
    buffer_load_dwordx4 v1, s[24:27], s47 offen offset:3072 sc1 lds
    s_waitcnt vmcnt(40)
    s_barrier
    s_mov_b32 m0, 65536
    s_add_u32 s47, s46, 65536
    buffer_load_dwordx4 v1, s[24:27], s47 offen offset:0 sc1 lds
    buffer_load_dwordx4 v1, s[24:27], s47 offen offset:1024 sc1 lds
    buffer_load_dwordx4 v1, s[24:27], s47 offen offset:2048 sc1 lds
    buffer_load_dwordx4 v1, s[24:27], s47 offen offset:3072 sc1 lds
    s_mov_b32 m0, 69632
    s_add_u32 s47, s46, 69632
    buffer_load_dwordx4 v1, s[24:27], s47 offen offset:0 sc1 lds
    buffer_load_dwordx4 v1, s[24:27], s47 offen offset:1024 sc1 lds
    buffer_load_dwordx4 v1, s[24:27], s47 offen offset:2048 sc1 lds
    buffer_load_dwordx4 v1, s[24:27], s47 offen offset:3072 sc1 lds
    s_mov_b32 m0, 73728
    s_add_u32 s47, s46, 73728
    buffer_load_dwordx4 v1, s[24:27], s47 offen offset:0 sc1 lds
    buffer_load_dwordx4 v1, s[24:27], s47 offen offset:1024 sc1 lds
    buffer_load_dwordx4 v1, s[24:27], s47 offen offset:2048 sc1 lds
    buffer_load_dwordx4 v1, s[24:27], s47 offen offset:3072 sc1 lds
    s_mov_b32 m0, 77824
    s_add_u32 s47, s46, 77824
    buffer_load_dwordx4 v1, s[24:27], s47 offen offset:0 sc1 lds
    buffer_load_dwordx4 v1, s[24:27], s47 offen offset:1024 sc1 lds
    buffer_load_dwordx4 v1, s[24:27], s47 offen offset:2048 sc1 lds
    buffer_load_dwordx4 v1, s[24:27], s47 offen offset:3072 sc1 lds
    s_mov_b32 m0, 81920
    s_add_u32 s47, s46, 81920
    buffer_load_dwordx4 v1, s[24:27], s47 offen offset:0 sc1 lds
    buffer_load_dwordx4 v1, s[24:27], s47 offen offset:1024 sc1 lds
    buffer_load_dwordx4 v1, s[24:27], s47 offen offset:2048 sc1 lds
    buffer_load_dwordx4 v1, s[24:27], s47 offen offset:3072 sc1 lds
    s_mov_b32 m0, 86016
    s_add_u32 s47, s46, 86016
    buffer_load_dwordx4 v1, s[24:27], s47 offen offset:0 sc1 lds
    buffer_load_dwordx4 v1, s[24:27], s47 offen offset:1024 sc1 lds
    buffer_load_dwordx4 v1, s[24:27], s47 offen offset:2048 sc1 lds
    buffer_load_dwordx4 v1, s[24:27], s47 offen offset:3072 sc1 lds
    s_mov_b32 m0, 90112
    s_add_u32 s47, s46, 90112
    buffer_load_dwordx4 v1, s[24:27], s47 offen offset:0 sc1 lds
    buffer_load_dwordx4 v1, s[24:27], s47 offen offset:1024 sc1 lds
    buffer_load_dwordx4 v1, s[24:27], s47 offen offset:2048 sc1 lds
    buffer_load_dwordx4 v1, s[24:27], s47 offen offset:3072 sc1 lds
    s_mov_b32 m0, 94208
    s_add_u32 s47, s46, 94208
    buffer_load_dwordx4 v1, s[24:27], s47 offen offset:0 sc1 lds
    buffer_load_dwordx4 v1, s[24:27], s47 offen offset:1024 sc1 lds
    buffer_load_dwordx4 v1, s[24:27], s47 offen offset:2048 sc1 lds
    buffer_load_dwordx4 v1, s[24:27], s47 offen offset:3072 sc1 lds
    s_mov_b32 m0, 98304
    s_add_u32 s47, s46, 98304
    buffer_load_dwordx4 v1, s[24:27], s47 offen offset:0 sc1 lds
    buffer_load_dwordx4 v1, s[24:27], s47 offen offset:1024 sc1 lds
    buffer_load_dwordx4 v1, s[24:27], s47 offen offset:2048 sc1 lds
    buffer_load_dwordx4 v1, s[24:27], s47 offen offset:3072 sc1 lds
    s_mov_b32 s55, 131072
L_p13:
    s_load_dwordx8 s[4:11], s[14:15], 32 glc
    s_load_dwordx8 s[16:23], s[14:15], 160 glc
    s_load_dwordx8 s[28:35], s[14:15], 288 glc
    s_load_dwordx8 s[56:63], s[14:15], 416 glc
L_pc13:
    s_sub_u32 s55, s55, 1
    s_cbranch_scc1 L_pd13
    s_waitcnt lgkmcnt(0)
    s_and_b64 s[4:5], s[4:5], s[16:17]
    s_and_b64 s[6:7], s[6:7], s[18:19]
    s_and_b64 s[8:9], s[8:9], s[20:21]
    s_and_b64 s[10:11], s[10:11], s[22:23]
    s_and_b64 s[4:5], s[4:5], s[28:29]
    s_and_b64 s[6:7], s[6:7], s[30:31]
    s_and_b64 s[8:9], s[8:9], s[32:33]
    s_and_b64 s[10:11], s[10:11], s[34:35]
    s_and_b64 s[4:5], s[4:5], s[56:57]
    s_and_b64 s[6:7], s[6:7], s[58:59]
    s_and_b64 s[8:9], s[8:9], s[60:61]
    s_and_b64 s[10:11], s[10:11], s[62:63]
    s_and_b64 s[4:5], s[4:5], s[6:7]
    s_and_b64 s[8:9], s[8:9], s[10:11]
    s_and_b64 s[4:5], s[4:5], s[8:9]
    s_and_b32 s4, s4, s5
    s_cmp_eq_u32 s4, 0
    s_cbranch_scc1 L_p13
L_pd13:
    ds_write_b32 v20, v4
    ds_write_b32 v11, v4
    s_waitcnt vmcnt(0) lgkmcnt(0)
    s_barrier
    buffer_store_dword v12, v14, s[24:27], s53 offen sc1
    s_load_dwordx8 s[4:11], s[14:15], 0 glc
    s_load_dwordx8 s[16:23], s[14:15], 128 glc
    s_load_dwordx8 s[28:35], s[14:15], 256 glc
    s_load_dwordx8 s[56:63], s[14:15], 384 glc
    s_mov_b32 s55, 131072
    s_branch L_pc14
L_p14:
    s_load_dwordx8 s[4:11], s[14:15], 0 glc
    s_load_dwordx8 s[16:23], s[14:15], 128 glc
    s_load_dwordx8 s[28:35], s[14:15], 256 glc
    s_load_dwordx8 s[56:63], s[14:15], 384 glc
L_pc14:
    s_sub_u32 s55, s55, 1
    s_cbranch_scc1 L_pd14
    s_waitcnt lgkmcnt(0)
    s_and_b64 s[4:5], s[4:5], s[6:7]
    s_and_b64 s[8:9], s[8:9], s[10:11]
    s_and_b64 s[4:5], s[4:5], s[8:9]
    s_and_b32 s4, s4, s5
    s_and_b64 s[16:17], s[16:17], s[18:19]
    s_and_b64 s[20:21], s[20:21], s[22:23]
    s_and_b64 s[16:17], s[16:17], s[20:21]
    s_and_b32 s16, s16, s17
    s_and_b64 s[28:29], s[28:29], s[30:31]
    s_and_b64 s[32:33], s[32:33], s[34:35]
    s_and_b64 s[28:29], s[28:29], s[32:33]
    s_and_b32 s28, s28, s29
    s_and_b64 s[56:57], s[56:57], s[58:59]
    s_and_b64 s[60:61], s[60:61], s[62:63]
    s_and_b64 s[56:57], s[56:57], s[60:61]
    s_and_b32 s56, s56, s57
    s_lshl1_add_u32 s47, s56, s28
    s_lshl1_add_u32 s47, s47, s16
    s_lshl1_add_u32 s47, s47, s4
    v_mov_b32 v10, s47
    ds_write_b32 v11, v10
    s_cmp_lg_u32 s47, 15
    s_cbranch_scc1 L_p14
L_pd14:
    v_mov_b32 v10, 15
    ds_write_b32 v11, v10
    s_waitcnt lgkmcnt(0)
    s_setprio 0
    s_mov_b32 s63, 131072
L_p15:
    ds_read_b32 v9, v20
L_pc15:
    s_sub_u32 s63, s63, 1
    s_cbranch_scc1 L_pd15
    s_waitcnt lgkmcnt(0)
    v_cmp_eq_u32 vcc, 0, v9
    s_cbranch_vccnz L_p15
L_pd15:
    buffer_store_dword v12, v14, s[24:27], s53 offen offset:64 sc1
    s_endpgm
.p2align 12
L_p3b:
L_again:
L_pad7:
    s_cbranch_execz L_padret
    s_mov_b32 s63, 131072
L_p1:
    ds_read_b32 v3, v2
L_pc1:
    s_sub_u32 s63, s63, 1
    s_cbranch_scc1 L_pd1
    s_waitcnt lgkmcnt(0)
    v_readfirstlane_b32 s47, v3
    s_andn2_b32 s50, s47, s55
    s_cmp_eq_u32 s50, 0
    s_cbranch_scc1 L_p1
L_pd1:
    v_readfirstlane_b32 s47, v3
    s_andn2_b32 s50, s47, s55
    s_cselect_b32 s8, 0, 2.0
    s_ff1_i32_b32 s4, s50
    v_bfi_b32 v4, 2.0, s8, v4
    v_bfi_b32 v7, 2.0, s8, v7
    s_bitset1_b32 s55, s4
    s_mul_i32 s56, s4, 10240
    s_add_u32 s56, s56, s48
    s_add_u32 s57, s56, 4096
    buffer_load_dwordx4 v[8:11], v4, s[24:27], s56 offen offset:0 sc1
    buffer_load_dwordx4 v[12:15], v4, s[24:27], s56 offen offset:2048 sc1
    buffer_load_dwordx4 v[16:19], v4, s[24:27], s57 offen offset:0 sc1
    buffer_load_dwordx4 v[20:23], v4, s[24:27], s57 offen offset:2048 sc1
    buffer_load_dwordx2 v[24:25], v7, s[24:27], s57 offen offset:0 sc1
    buffer_load_dwordx2 v[26:27], v7, s[24:27], s57 offen offset:256 sc1
    s_mul_i32 s53, s4, 25600
    v_add_u32 v0, s53, v1
    ds_read_b128 v[48:51], v0 offset:0
    ds_read_b128 v[52:55], v0 offset:1024
    ds_read_b128 v[56:59], v0 offset:2048
    ds_read_b128 v[60:63], v0 offset:3072
    ds_read_b128 v[64:67], v0 offset:4096
    ds_read_b128 v[68:71], v0 offset:5120
    ds_read_b128 v[72:75], v0 offset:6144
    ds_read_b128 v[76:79], v0 offset:7168
    ds_read_b128 v[80:83], v0 offset:8192
    ds_read_b128 v[84:87], v0 offset:9216
    s_andn2_b32 s50, s47, s55
    s_cbranch_scc1 L_nx0
    s_waitcnt vmcnt(5)
L_rr0:
    ds_read_b32 v3, v2
    s_waitcnt lgkmcnt(0)
L_nx0:
    v_readfirstlane_b32 s47, v3
    s_andn2_b32 s50, s47, s55
    s_cselect_b32 s9, 0, 2.0
    s_ff1_i32_b32 s5, s50
    v_bfi_b32 v4, 2.0, s9, v4
    v_bfi_b32 v7, 2.0, s9, v7
    s_bitset1_b32 s55, s5
    s_mul_i32 s56, s5, 10240
    s_add_u32 s56, s56, s48
    s_add_u32 s57, s56, 4096
    buffer_load_dwordx4 v[28:31], v4, s[24:27], s56 offen offset:0 sc1
    buffer_load_dwordx4 v[32:35], v4, s[24:27], s56 offen offset:2048 sc1
    buffer_load_dwordx4 v[36:39], v4, s[24:27], s57 offen offset:0 sc1
    buffer_load_dwordx4 v[40:43], v4, s[24:27], s57 offen offset:2048 sc1
    buffer_load_dwordx2 v[44:45], v7, s[24:27], s57 offen offset:0 sc1
    buffer_load_dwordx2 v[46:47], v7, s[24:27], s57 offen offset:256 sc1
L_go0:
    s_waitcnt vmcnt(11) lgkmcnt(5)
    v_mfma_f32_16x16x32_bf16 v[88:91], v[48:51], v[8:11], 0
    ds_read_b128 v[48:51], v0 offset:10240
    v_readfirstlane_b32 s47, v3
    v_mfma_f32_16x16x32_bf16 v[92:95], v[52:55], v[8:11], 0
    ds_read_b128 v[52:55], v0 offset:11264
    s_andn2_b32 s50, s47, s55
    v_mfma_f32_16x16x32_bf16 v[96:99], v[56:59], v[8:11], 0
    ds_read_b128 v[56:59], v0 offset:12288
    s_cselect_b32 s10, 0, 2.0
    v_mfma_f32_16x16x32_bf16 v[100:103], v[60:63], v[8:11], 0
    ds_read_b128 v[60:63], v0 offset:13312
    s_ff1_i32_b32 s6, s50
    v_mfma_f32_16x16x32_bf16 v[104:107], v[64:67], v[8:11], 0
    ds_read_b128 v[64:67], v0 offset:14336
    s_waitcnt vmcnt(10) lgkmcnt(5)
    v_mfma_f32_16x16x32_bf16 v[88:91], v[68:71], v[12:15], v[88:91]
    ds_read_b128 v[68:71], v0 offset:15360
    v_bfi_b32 v4, 2.0, s10, v4
    v_mfma_f32_16x16x32_bf16 v[92:95], v[72:75], v[12:15], v[92:95]
    ds_read_b128 v[72:75], v0 offset:16384
    v_bfi_b32 v7, 2.0, s10, v7
    v_mfma_f32_16x16x32_bf16 v[96:99], v[76:79], v[12:15], v[96:99]
    ds_read_b128 v[76:79], v0 offset:17408
    s_bitset1_b32 s55, s6
    v_mfma_f32_16x16x32_bf16 v[100:103], v[80:83], v[12:15], v[100:103]
    ds_read_b128 v[80:83], v0 offset:18432
    s_mul_i32 s59, s6, 10240
    v_mfma_f32_16x16x32_bf16 v[104:107], v[84:87], v[12:15], v[104:107]
    ds_read_b128 v[84:87], v0 offset:19456
    s_waitcnt vmcnt(9) lgkmcnt(5)
    v_mfma_f32_16x16x32_bf16 v[88:91], v[48:51], v[16:19], v[88:91]
    ds_read_b128 v[48:51], v0 offset:20480
    s_add_u32 s59, s59, s48
    v_mfma_f32_16x16x32_bf16 v[92:95], v[52:55], v[16:19], v[92:95]
    ds_read_b128 v[52:55], v0 offset:21504
    s_add_u32 s60, s59, 4096
    v_mfma_f32_16x16x32_bf16 v[96:99], v[56:59], v[16:19], v[96:99]
    ds_read_b128 v[56:59], v0 offset:22528
    buffer_load_dwordx4 v[8:11], v4, s[24:27], s59 offen offset:0 sc1
    v_mfma_f32_16x16x32_bf16 v[100:103], v[60:63], v[16:19], v[100:103]
    ds_read_b128 v[60:63], v0 offset:23552
    buffer_load_dwordx4 v[12:15], v4, s[24:27], s59 offen offset:2048 sc1
    v_mfma_f32_16x16x32_bf16 v[104:107], v[64:67], v[16:19], v[104:107]
    ds_read_b128 v[64:67], v0 offset:24576
    s_waitcnt vmcnt(10) lgkmcnt(5)
    s_mul_i32 s53, s5, 25600
    v_mfma_f32_16x16x32_bf16 v[88:91], v[68:71], v[20:23], v[88:91]
    v_add_u32 v0, s53, v1
    ds_read_b128 v[68:71], v0 offset:0
    v_mfma_f32_16x16x32_bf16 v[92:95], v[72:75], v[20:23], v[92:95]
    ds_read_b128 v[72:75], v0 offset:1024
    v_mfma_f32_16x16x32_bf16 v[96:99], v[76:79], v[20:23], v[96:99]
    ds_read_b128 v[76:79], v0 offset:2048
    buffer_load_dwordx4 v[16:19], v4, s[24:27], s60 offen offset:0 sc1
    v_mfma_f32_16x16x32_bf16 v[100:103], v[80:83], v[20:23], v[100:103]
    ds_read_b128 v[80:83], v0 offset:3072
    ds_read_b32 v3, v2
    v_mfma_f32_16x16x32_bf16 v[104:107], v[84:87], v[20:23], v[104:107]
    ds_read_b128 v[84:87], v0 offset:4096
    s_waitcnt vmcnt(9) lgkmcnt(6)
    v_mfma_f32_16x16x32_bf16 v[88:91], v[48:51], v[24:27], v[88:91]
    ds_read_b128 v[48:51], v0 offset:5120
    v_mfma_f32_16x16x32_bf16 v[92:95], v[52:55], v[24:27], v[92:95]
    ds_read_b128 v[52:55], v0 offset:6144
    buffer_load_dwordx4 v[20:23], v4, s[24:27], s60 offen offset:2048 sc1
    v_mfma_f32_16x16x32_bf16 v[96:99], v[56:59], v[24:27], v[96:99]
    ds_read_b128 v[56:59], v0 offset:7168
    v_mfma_f32_16x16x32_bf16 v[100:103], v[60:63], v[24:27], v[100:103]
    ds_read_b128 v[60:63], v0 offset:8192
    s_cmp_lg_u32 s10, 0
    v_mfma_f32_16x16x32_bf16 v[104:107], v[64:67], v[24:27], v[104:107]
    ds_read_b128 v[64:67], v0 offset:9216
    buffer_load_dwordx2 v[24:25], v7, s[24:27], s60 offen offset:0 sc1
    buffer_load_dwordx2 v[26:27], v7, s[24:27], s60 offen offset:256 sc1
    s_cbranch_scc1 L_x1
L_go1:
    s_waitcnt vmcnt(11) lgkmcnt(5)
    v_mfma_f32_16x16x32_bf16 v[108:111], v[68:71], v[28:31], 0
    ds_read_b128 v[68:71], v0 offset:10240
    v_readfirstlane_b32 s47, v3
    v_mfma_f32_16x16x32_bf16 v[112:115], v[72:75], v[28:31], 0
    ds_read_b128 v[72:75], v0 offset:11264
    s_andn2_b32 s50, s47, s55
    v_mfma_f32_16x16x32_bf16 v[116:119], v[76:79], v[28:31], 0
    ds_read_b128 v[76:79], v0 offset:12288
    s_cselect_b32 s11, 0, 2.0
    v_mfma_f32_16x16x32_bf16 v[120:123], v[80:83], v[28:31], 0
    ds_read_b128 v[80:83], v0 offset:13312
    s_ff1_i32_b32 s7, s50
    v_mfma_f32_16x16x32_bf16 v[124:127], v[84:87], v[28:31], 0
    ds_read_b128 v[84:87], v0 offset:14336
    s_waitcnt vmcnt(10) lgkmcnt(5)
    v_mfma_f32_16x16x32_bf16 v[108:111], v[48:51], v[32:35], v[108:111]
    ds_read_b128 v[48:51], v0 offset:15360
    v_bfi_b32 v4, 2.0, s11, v4
    v_mfma_f32_16x16x32_bf16 v[112:115], v[52:55], v[32:35], v[112:115]
    ds_read_b128 v[52:55], v0 offset:16384
    v_bfi_b32 v7, 2.0, s11, v7
    v_mfma_f32_16x16x32_bf16 v[116:119], v[56:59], v[32:35], v[116:119]
    ds_read_b128 v[56:59], v0 offset:17408
    s_bitset1_b32 s55, s7
    v_mfma_f32_16x16x32_bf16 v[120:123], v[60:63], v[32:35], v[120:123]
    ds_read_b128 v[60:63], v0 offset:18432
    s_mul_i32 s59, s7, 10240
    v_mfma_f32_16x16x32_bf16 v[124:127], v[64:67], v[32:35], v[124:127]
    ds_read_b128 v[64:67], v0 offset:19456
    s_waitcnt vmcnt(9) lgkmcnt(5)
    v_mfma_f32_16x16x32_bf16 v[108:111], v[68:71], v[36:39], v[108:111]
    ds_read_b128 v[68:71], v0 offset:20480
    s_add_u32 s59, s59, s48
    v_mfma_f32_16x16x32_bf16 v[112:115], v[72:75], v[36:39], v[112:115]
    ds_read_b128 v[72:75], v0 offset:21504
    s_add_u32 s60, s59, 4096
    v_mfma_f32_16x16x32_bf16 v[116:119], v[76:79], v[36:39], v[116:119]
    ds_read_b128 v[76:79], v0 offset:22528
    buffer_load_dwordx4 v[28:31], v4, s[24:27], s59 offen offset:0 sc1
    v_mfma_f32_16x16x32_bf16 v[120:123], v[80:83], v[36:39], v[120:123]
    ds_read_b128 v[80:83], v0 offset:23552
    buffer_load_dwordx4 v[32:35], v4, s[24:27], s59 offen offset:2048 sc1
    v_mfma_f32_16x16x32_bf16 v[124:127], v[84:87], v[36:39], v[124:127]
    ds_read_b128 v[84:87], v0 offset:24576
    s_waitcnt vmcnt(10) lgkmcnt(5)
    s_mul_i32 s53, s6, 25600
    v_mfma_f32_16x16x32_bf16 v[108:111], v[48:51], v[40:43], v[108:111]
    v_add_u32 v0, s53, v1
    ds_read_b128 v[48:51], v0 offset:0
    v_mfma_f32_16x16x32_bf16 v[112:115], v[52:55], v[40:43], v[112:115]
    ds_read_b128 v[52:55], v0 offset:1024
    v_mfma_f32_16x16x32_bf16 v[116:119], v[56:59], v[40:43], v[116:119]
    ds_read_b128 v[56:59], v0 offset:2048
    buffer_load_dwordx4 v[36:39], v4, s[24:27], s60 offen offset:0 sc1
    v_mfma_f32_16x16x32_bf16 v[120:123], v[60:63], v[40:43], v[120:123]
    ds_read_b128 v[60:63], v0 offset:3072
    ds_read_b32 v3, v2
    v_mfma_f32_16x16x32_bf16 v[124:127], v[64:67], v[40:43], v[124:127]
    ds_read_b128 v[64:67], v0 offset:4096
    s_waitcnt vmcnt(9) lgkmcnt(6)
    v_mfma_f32_16x16x32_bf16 v[108:111], v[68:71], v[44:47], v[108:111]
    ds_read_b128 v[68:71], v0 offset:5120
    v_mfma_f32_16x16x32_bf16 v[112:115], v[72:75], v[44:47], v[112:115]
    ds_read_b128 v[72:75], v0 offset:6144
    buffer_load_dwordx4 v[40:43], v4, s[24:27], s60 offen offset:2048 sc1
    v_mfma_f32_16x16x32_bf16 v[116:119], v[76:79], v[44:47], v[116:119]
    ds_read_b128 v[76:79], v0 offset:7168
    v_mfma_f32_16x16x32_bf16 v[120:123], v[80:83], v[44:47], v[120:123]
    ds_read_b128 v[80:83], v0 offset:8192
    s_cmp_lg_u32 s11, 0
    v_mfma_f32_16x16x32_bf16 v[124:127], v[84:87], v[44:47], v[124:127]
    ds_read_b128 v[84:87], v0 offset:9216
    buffer_load_dwordx2 v[44:45], v7, s[24:27], s60 offen offset:0 sc1
    buffer_load_dwordx2 v[46:47], v7, s[24:27], s60 offen offset:256 sc1
    s_cbranch_scc1 L_x2
L_go2:
    s_waitcnt vmcnt(11) lgkmcnt(5)
    v_mfma_f32_16x16x32_bf16 v[128:131], v[48:51], v[8:11], 0
    ds_read_b128 v[48:51], v0 offset:10240
    s_lshl2_add_u32 s47, s40, 127232
    v_mfma_f32_16x16x32_bf16 v[132:135], v[52:55], v[8:11], 0
    ds_read_b128 v[52:55], v0 offset:11264
    v_mov_b32 v3, s47
    v_mfma_f32_16x16x32_bf16 v[136:139], v[56:59], v[8:11], 0
    ds_read_b128 v[56:59], v0 offset:12288
    ds_write_b32 v3, v2
    v_mfma_f32_16x16x32_bf16 v[140:143], v[60:63], v[8:11], 0
    ds_read_b128 v[60:63], v0 offset:13312
    v_mfma_f32_16x16x32_bf16 v[144:147], v[64:67], v[8:11], 0
    ds_read_b128 v[64:67], v0 offset:14336
    s_waitcnt vmcnt(10) lgkmcnt(6)
    v_mfma_f32_16x16x32_bf16 v[128:131], v[68:71], v[12:15], v[128:131]
    ds_read_b128 v[68:71], v0 offset:15360
    v_mfma_f32_16x16x32_bf16 v[132:135], v[72:75], v[12:15], v[132:135]
    ds_read_b128 v[72:75], v0 offset:16384
    v_mfma_f32_16x16x32_bf16 v[136:139], v[76:79], v[12:15], v[136:139]
    ds_read_b128 v[76:79], v0 offset:17408
    v_mfma_f32_16x16x32_bf16 v[140:143], v[80:83], v[12:15], v[140:143]
    ds_read_b128 v[80:83], v0 offset:18432
    v_mfma_f32_16x16x32_bf16 v[144:147], v[84:87], v[12:15], v[144:147]
    ds_read_b128 v[84:87], v0 offset:19456
    s_waitcnt vmcnt(9) lgkmcnt(5)
    v_mfma_f32_16x16x32_bf16 v[128:131], v[48:51], v[16:19], v[128:131]
    ds_read_b128 v[48:51], v0 offset:20480
    v_mfma_f32_16x16x32_bf16 v[132:135], v[52:55], v[16:19], v[132:135]
    ds_read_b128 v[52:55], v0 offset:21504
    v_mfma_f32_16x16x32_bf16 v[136:139], v[56:59], v[16:19], v[136:139]
    ds_read_b128 v[56:59], v0 offset:22528
    v_mfma_f32_16x16x32_bf16 v[140:143], v[60:63], v[16:19], v[140:143]
    ds_read_b128 v[60:63], v0 offset:23552
    v_mfma_f32_16x16x32_bf16 v[144:147], v[64:67], v[16:19], v[144:147]
    ds_read_b128 v[64:67], v0 offset:24576
    s_waitcnt vmcnt(8) lgkmcnt(5)
    s_mul_i32 s53, s7, 25600
    v_mfma_f32_16x16x32_bf16 v[128:131], v[68:71], v[20:23], v[128:131]
    v_add_u32 v0, s53, v1
    ds_read_b128 v[68:71], v0 offset:0
    v_mfma_f32_16x16x32_bf16 v[132:135], v[72:75], v[20:23], v[132:135]
    ds_read_b128 v[72:75], v0 offset:1024
    v_mfma_f32_16x16x32_bf16 v[136:139], v[76:79], v[20:23], v[136:139]
    ds_read_b128 v[76:79], v0 offset:2048
    v_mfma_f32_16x16x32_bf16 v[140:143], v[80:83], v[20:23], v[140:143]
    ds_read_b128 v[80:83], v0 offset:3072
    v_mfma_f32_16x16x32_bf16 v[144:147], v[84:87], v[20:23], v[144:147]
    ds_read_b128 v[84:87], v0 offset:4096
    s_waitcnt vmcnt(6) lgkmcnt(5)
    v_mfma_f32_16x16x32_bf16 v[128:131], v[48:51], v[24:27], v[128:131]
    ds_read_b128 v[48:51], v0 offset:5120
    v_mfma_f32_16x16x32_bf16 v[132:135], v[52:55], v[24:27], v[132:135]
    ds_read_b128 v[52:55], v0 offset:6144
    v_mfma_f32_16x16x32_bf16 v[136:139], v[56:59], v[24:27], v[136:139]
    ds_read_b128 v[56:59], v0 offset:7168
    v_mfma_f32_16x16x32_bf16 v[140:143], v[60:63], v[24:27], v[140:143]
    ds_read_b128 v[60:63], v0 offset:8192
    s_cmp_lg_u32 s11, 0
    v_mfma_f32_16x16x32_bf16 v[144:147], v[64:67], v[24:27], v[144:147]
    ds_read_b128 v[64:67], v0 offset:9216
    s_cbranch_scc1 L_x3
L_go3:
    s_xor_b32 s47, s4, 1
    s_cmp_lg_u32 s47, s5
    s_cbranch_scc1 L_t23
L_t3:
    s_waitcnt vmcnt(5) lgkmcnt(5)
    v_mfma_f32_16x16x32_bf16 v[148:151], v[68:71], v[28:31], 0
    ds_read_b128 v[68:71], v0 offset:10240
    v_add_f32 v88, v88, v108
    v_mfma_f32_16x16x32_bf16 v[152:155], v[72:75], v[28:31], 0
    ds_read_b128 v[72:75], v0 offset:11264
    v_add_f32 v89, v89, v109
    v_mfma_f32_16x16x32_bf16 v[156:159], v[76:79], v[28:31], 0
    ds_read_b128 v[76:79], v0 offset:12288
    v_add_f32 v90, v90, v110
    v_mfma_f32_16x16x32_bf16 v[160:163], v[80:83], v[28:31], 0
    ds_read_b128 v[80:83], v0 offset:13312
    v_add_f32 v91, v91, v111
    v_mfma_f32_16x16x32_bf16 v[164:167], v[84:87], v[28:31], 0
    ds_read_b128 v[84:87], v0 offset:14336
    s_waitcnt vmcnt(4) lgkmcnt(5)
    v_mfma_f32_16x16x32_bf16 v[148:151], v[48:51], v[32:35], v[148:151]
    ds_read_b128 v[48:51], v0 offset:15360
    v_add_f32 v92, v92, v112
    v_mfma_f32_16x16x32_bf16 v[152:155], v[52:55], v[32:35], v[152:155]
    ds_read_b128 v[52:55], v0 offset:16384
    v_add_f32 v93, v93, v113
    v_mfma_f32_16x16x32_bf16 v[156:159], v[56:59], v[32:35], v[156:159]
    ds_read_b128 v[56:59], v0 offset:17408
    v_add_f32 v94, v94, v114
    v_mfma_f32_16x16x32_bf16 v[160:163], v[60:63], v[32:35], v[160:163]
    ds_read_b128 v[60:63], v0 offset:18432
    v_add_f32 v95, v95, v115
    v_mfma_f32_16x16x32_bf16 v[164:167], v[64:67], v[32:35], v[164:167]
    ds_read_b128 v[64:67], v0 offset:19456
    s_waitcnt vmcnt(3) lgkmcnt(5)
    v_mfma_f32_16x16x32_bf16 v[148:151], v[68:71], v[36:39], v[148:151]
    ds_read_b128 v[68:71], v0 offset:20480
    v_add_f32 v96, v96, v116
    v_mfma_f32_16x16x32_bf16 v[152:155], v[72:75], v[36:39], v[152:155]
    ds_read_b128 v[72:75], v0 offset:21504
    v_add_f32 v97, v97, v117
    v_mfma_f32_16x16x32_bf16 v[156:159], v[76:79], v[36:39], v[156:159]
    ds_read_b128 v[76:79], v0 offset:22528
    v_add_f32 v98, v98, v118
    v_mfma_f32_16x16x32_bf16 v[160:163], v[80:83], v[36:39], v[160:163]
    ds_read_b128 v[80:83], v0 offset:23552
    v_add_f32 v99, v99, v119
    v_mfma_f32_16x16x32_bf16 v[164:167], v[84:87], v[36:39], v[164:167]
    ds_read_b128 v[84:87], v0 offset:24576
    s_waitcnt vmcnt(2) lgkmcnt(5)
    v_mfma_f32_16x16x32_bf16 v[148:151], v[48:51], v[40:43], v[148:151]
    v_add_f32 v100, v100, v120
    v_mfma_f32_16x16x32_bf16 v[152:155], v[52:55], v[40:43], v[152:155]
    v_add_f32 v101, v101, v121
    v_mfma_f32_16x16x32_bf16 v[156:159], v[56:59], v[40:43], v[156:159]
    v_add_f32 v102, v102, v122
    v_mfma_f32_16x16x32_bf16 v[160:163], v[60:63], v[40:43], v[160:163]
    v_add_f32 v103, v103, v123
    v_mfma_f32_16x16x32_bf16 v[164:167], v[64:67], v[40:43], v[164:167]
    s_waitcnt vmcnt(0) lgkmcnt(0)
    v_mfma_f32_16x16x32_bf16 v[148:151], v[68:71], v[44:47], v[148:151]
    v_add_f32 v104, v104, v124
    v_mfma_f32_16x16x32_bf16 v[152:155], v[72:75], v[44:47], v[152:155]
    v_add_f32 v105, v105, v125
    v_mfma_f32_16x16x32_bf16 v[156:159], v[76:79], v[44:47], v[156:159]
    v_add_f32 v106, v106, v126
    v_mfma_f32_16x16x32_bf16 v[160:163], v[80:83], v[44:47], v[160:163]
    v_add_f32 v107, v107, v127
    v_mfma_f32_16x16x32_bf16 v[164:167], v[84:87], v[44:47], v[164:167]
    s_nop 3
    v_pk_add_f32 v[148:149], v[148:149], v[128:129]
    v_pk_add_f32 v[150:151], v[150:151], v[130:131]
    v_pk_add_f32 v[152:153], v[152:153], v[132:133]
    v_pk_add_f32 v[154:155], v[154:155], v[134:135]
    v_pk_add_f32 v[148:149], v[148:149], v[88:89]
    v_pk_add_f32 v[150:151], v[150:151], v[90:91]
    v_pk_add_f32 v[152:153], v[152:153], v[92:93]
    v_pk_add_f32 v[154:155], v[154:155], v[94:95]
    v_cvt_pk_bf16_f32 v8, v148, v149
    v_cvt_pk_bf16_f32 v9, v150, v151
    v_cvt_pk_bf16_f32 v10, v152, v153
    v_cvt_pk_bf16_f32 v11, v154, v155
    buffer_store_dwordx4 v[8:11], v5, s[32:35], 0 offen offset:0
    v_pk_add_f32 v[156:157], v[156:157], v[136:137]
    v_pk_add_f32 v[158:159], v[158:159], v[138:139]
    v_pk_add_f32 v[160:161], v[160:161], v[140:141]
    v_pk_add_f32 v[162:163], v[162:163], v[142:143]
    v_pk_add_f32 v[156:157], v[156:157], v[96:97]
    v_pk_add_f32 v[158:159], v[158:159], v[98:99]
    v_pk_add_f32 v[160:161], v[160:161], v[100:101]
    v_pk_add_f32 v[162:163], v[162:163], v[102:103]
    v_cvt_pk_bf16_f32 v12, v156, v157
    v_cvt_pk_bf16_f32 v13, v158, v159
    v_cvt_pk_bf16_f32 v14, v160, v161
    v_cvt_pk_bf16_f32 v15, v162, v163
    buffer_store_dwordx4 v[12:15], v5, s[32:35], 0 offen offset:64
    v_pk_add_f32 v[164:165], v[164:165], v[144:145]
    v_pk_add_f32 v[166:167], v[166:167], v[146:147]
    v_pk_add_f32 v[164:165], v[164:165], v[104:105]
    v_pk_add_f32 v[166:167], v[166:167], v[106:107]
    v_cvt_pk_bf16_f32 v16, v164, v165
    v_cvt_pk_bf16_f32 v17, v166, v167
    buffer_store_dwordx2 v[16:17], v6, s[32:35], 0 offen offset:128
    s_movk_i32 s47, 0x207
    v_cmp_class_f32 vcc, v148, s47
    s_cmp_lg_u32 s54, 0
    s_cbranch_scc1 L_exit
    s_cbranch_vccnz L_retry
L_exit:
L_end:
    s_endpgm
.section .rodata,"a"
.p2align 6
.amdhsa_kernel standalone__softmax_full_mha__prompt_kernel
  .amdhsa_next_free_vgpr 168
  .amdhsa_next_free_sgpr 96
  .amdhsa_accum_offset 168
  .amdhsa_group_segment_fixed_size 0
  .amdhsa_kernarg_size 48
  .amdhsa_user_sgpr_count 2
  .amdhsa_user_sgpr_kernarg_segment_ptr 1
  .amdhsa_system_sgpr_workgroup_id_x 1
.end_amdhsa_kernel
```
